```python
import torch

def _softmax(x, axis=-1):
    return torch.softmax(x, dim=axis)
def _gelu(x):
    return torch.nn.functional.gelu(x, approximate="tanh")
def _silu(x):
    return torch.nn.functional.silu(x)
def _sigmoid(x):
    return torch.sigmoid(x)
def _layernorm(x, axis=-1, eps=1e-5):
    m = x.mean(dim=axis, keepdim=True)
    v = x.var(dim=axis, keepdim=True, unbiased=False)
    return (x - m) / torch.sqrt(v + eps)
def _scatter_add(tgt, idx, src, axis=0):
    return tgt.clone().index_add_(axis, idx, src)
def _segment_sum(src, seg, n):
    out = torch.zeros((n,) + src.shape[1:], dtype=src.dtype)
    return out.index_add_(0, seg, src)
def _pad(x, pw):
    flat = tuple(v for pair in reversed(pw) for v in pair)
    return torch.nn.functional.pad(x, flat)

kernel_name = 'concat_heads__linear_attn_block__ssm_conv_h3__prompt'

def setup_inputs():

    _w = (lambda a: (lambda t: t.to(torch.bfloat16) if t.is_floating_point() else t)(torch.as_tensor(a)))
    def _A_setup():
        B, S, D = 1, 2048, 576
        return {
            "x": _w((lambda *s: torch.randn(*s, dtype=torch.bfloat16) * 0.05)(B, S, D)),
            "wqkv": _w((lambda *s: torch.randn(*s, dtype=torch.bfloat16) * 0.8)(D, 3 * D)),
            "wo": _w((lambda *s: torch.randn(*s, dtype=torch.bfloat16) * 0.05)(D, D)),
        }
    _A_in = _A_setup()

    def _B_setup():
        B, S, D = 1, 2048, 576
        ks = 4
        return {
            "q": _w((lambda *s: torch.randn(*s, dtype=torch.bfloat16) * 0.05)(B, S, D)),
            "k": _w((lambda *s: torch.randn(*s, dtype=torch.bfloat16) * 0.4)(B, S, D)),
            "v": _w((lambda *s: torch.randn(*s, dtype=torch.bfloat16) * 0.4)(B, S, D)),
            "shift_k": _w((lambda *s: torch.randn(*s, dtype=torch.bfloat16) * 0.4)(D, ks) * 0.5),
            "ssm_k": _w((lambda *s: torch.randn(*s, dtype=torch.bfloat16) * 1.6)(D, S) * (1.0 / S ** 0.5)),
            "ssm_D": _w((lambda *s: torch.randn(*s, dtype=torch.bfloat16) * 0.4)(D)),
        }
    _B_in = _B_setup()

    return {
        "A_x": _A_in["x"],
        "A_wqkv": _A_in["wqkv"],
        "A_wo": _A_in["wo"],
        "B_q": _B_in["q"],
        "B_k": _B_in["k"],
        "B_v": _B_in["v"],
        "B_shift_k": _B_in["shift_k"],
        "B_ssm_k": _B_in["ssm_k"],
        "B_ssm_D": _B_in["ssm_D"],
    }

def reference(A_x, A_wqkv, A_wo, B_q, B_k, B_v, B_shift_k, B_ssm_k, B_ssm_D):
    def _A_ref(x, wqkv, wo):
        B, S, D = x.shape
        H = 32; Dh = D // H
        qkv = (lambda x, *d: x.permute(*d))((x @ wqkv).reshape(B, S, 3, H, Dh), 2, 0, 3, 1, 4)
        q, k, v = qkv[0], qkv[1], qkv[2]
        phi = lambda t: torch.where(t > 0, t + 1, torch.exp(t)) + 1e-6
        pq, pk = phi(q), phi(k)
        kv = torch.einsum("bhsd,bhse->bhde", pk, v)
        z = torch.einsum("bhsd->bhd", pk)
        num = torch.einsum("bhqd,bhde->bhqe", pq, kv)
        den = torch.einsum("bhqd,bhd->bhq", pq, z)[..., None] + 1e-6
        o = num / den
        return (lambda x, *d: x.permute(*d))(o, 0, 2, 1, 3).reshape(B, S, D) @ wo

    def _B_ref(q, k, v, shift_k, ssm_k, ssm_D):
        B, S, D = q.shape
        ks = shift_k.shape[-1]
        k_pad = _pad(k, ((0, 0), (ks - 1, 0), (0, 0)))
        k_shift = torch.zeros_like(k)
        for t in range(ks):
            k_shift = k_shift + k_pad[:, t:t + S, :] * shift_k[:, ks - 1 - t][None, None, :]
        kv = k_shift * v
        L = 2 * S
        kv_pad = _pad(kv, ((0, 0), (0, S), (0, 0)))
        kf_pad = _pad(ssm_k, ((0, 0), (0, S)))
        kv_f = (lambda x, axes=(-2,-1): torch.fft.rfft2(x.float(), dim=axes))(kv_pad[:, None, :, :], axes=(1, 2))
        kf_f = (lambda x, axes=(-2,-1): torch.fft.rfft2(x.float(), dim=axes))(kf_pad[:, None, :], axes=(1, 2))
        kf_f = (lambda x, *d: x.permute(*d))(kf_f, 1, 2, 0)
        y_f = kv_f * kf_f[None, :, :, :]
        y = (lambda x, s, axes=(-2,-1): torch.fft.irfft2(x, s=s, dim=axes).to(torch.bfloat16))(y_f, (1, L), axes=(1, 2))[:, 0, :S, :]
        y = y + kv * ssm_D[None, None, :]
        return q * y

    a = _A_ref(A_x, A_wqkv, A_wo)
    b = _B_ref(B_q, B_k, B_v, B_shift_k, B_ssm_k, B_ssm_D)
    return torch.concatenate([a, b], axis=-1)
```

```asm
; @launch grid=(249,1,1) block=(512,1,1) lds=163840
.amdgcn_target "amdgcn-amd-amdhsa--gfx950"
.text
.globl concat_heads__linear_attn_block__ssm_conv_h3__prompt_kernel
.p2align 8
.type concat_heads__linear_attn_block__ssm_conv_h3__prompt_kernel,@function
concat_heads__linear_attn_block__ssm_conv_h3__prompt_kernel:
    s_cmp_ge_u32 s2, 249
    s_cbranch_scc1 L_concat_heads__linear_attn_block__ssm_conv_h3__prompt_kernel_exit
    s_load_dwordx16 s[40:55], s[0:1], 0
    s_load_dwordx8 s[56:63], s[0:1], 64
    v_lshrrev_b32 v1, 6, v0
    s_nop 0
    v_readfirstlane_b32 s3, v1
    v_and_b32 v1, 63, v0
    s_cmp_eq_u32 s3, 3
    s_cbranch_scc0 L_nopf
    s_getpc_b64 s[20:21]
L_pf_k:
    s_sub_u32 s20, s20, L_pf_k-concat_heads__linear_attn_block__ssm_conv_h3__prompt_kernel
    s_subb_u32 s21, s21, 0
    s_lshr_b32 s22, s2, 3
    s_and_b32 s22, s22, 31
    s_mul_i32 s22, s22, ((L_concat_heads__linear_attn_block__ssm_conv_h3__prompt_kernel_exit-concat_heads__linear_attn_block__ssm_conv_h3__prompt_kernel+4095)/4096)
    v_add_u32 v2, s22, v1
    v_lshlrev_b32 v2, 7, v2
    v_cmp_gt_u32 vcc, ((L_concat_heads__linear_attn_block__ssm_conv_h3__prompt_kernel_exit-concat_heads__linear_attn_block__ssm_conv_h3__prompt_kernel+4095)/4096), v1
    s_and_saveexec_b64 s[22:23], vcc
    global_load_dword v255, v2, s[20:21]
    s_mov_b64 exec, -1
L_nopf:
    s_waitcnt lgkmcnt(0)
    s_cmp_ge_u32 s2, 176
    s_cbranch_scc1 L_roleB
    s_cmp_ge_u32 s2, 128
    s_cbranch_scc1 L_roleQ
    s_and_b32 s20, s2, 7
    s_lshr_b32 s21, s2, 3
    s_lshr_b32 s22, s20, 1
    s_lshl_b32 s22, s22, 2
    s_and_b32 s23, s21, 3
    s_add_u32 s22, s22, s23
    s_and_b32 s23, s20, 1
    s_lshl_b32 s23, s23, 2
    s_lshr_b32 s24, s21, 2
    s_add_u32 s23, s23, s24
    s_cmp_ge_u32 s3, 4
    s_cbranch_scc0 L_g1kv_compute
    s_sub_u32 s25, s3, 4
    s_mov_b32 s12, s40
    s_and_b32 s13, s41, 0xffff
    s_mov_b32 s14, 2359296
    s_mov_b32 s15, 0x20000
    s_mov_b32 s16, s42
    s_and_b32 s17, s43, 0xffff
    s_mov_b32 s18, 1990656
    s_mov_b32 s19, 0x20000
    v_lshrrev_b32 v2, 3, v1
    v_and_b32 v3, 7, v1
    v_xor_b32 v3, v3, v2
    v_lshlrev_b32 v3, 4, v3
    v_mul_u32_u24 v2, 1152, v2
    v_add_u32 v2, v2, v3
    s_lshl_b32 s26, s22, 7
    s_lshl_b32 s27, s25, 3
    s_add_u32 s26, s26, s27
    s_mul_i32 s26, s26, 1152
    s_lshl_b32 s29, s25, 10
    s_add_u32 m0, s29, 0
    s_add_u32 s31, s26, 0
    buffer_load_dwordx4 v2, s[12:15], s31 offen lds
    s_add_u32 m0, s29, 4096
    s_add_u32 s31, s26, 36864
    buffer_load_dwordx4 v2, s[12:15], s31 offen lds
    s_add_u32 m0, s29, 8192
    s_add_u32 s31, s26, 73728
    buffer_load_dwordx4 v2, s[12:15], s31 offen lds
    s_add_u32 m0, s29, 12288
    s_add_u32 s31, s26, 110592
    buffer_load_dwordx4 v2, s[12:15], s31 offen lds
    s_mov_b32 s28, 0
    s_lshl_b32 s30, s25, 6
    s_mul_i32 s33, s23, 144
    s_add_u32 s34, s33, 1152
    s_add_u32 s35, s33, 2160
    v_mov_b32 v10, s34
    v_mov_b32 v11, s35
    v_add_u32 v12, s30, v1
    v_mul_u32_u24 v13, 3641, v12
    v_lshrrev_b32 v13, 16, v13
    v_mul_u32_u24 v14, 18, v13
    v_sub_u32 v12, v12, v14
    v_and_b32 v14, 8, v13
    v_xor_b32 v14, v14, v12
    v_cmp_gt_u32 vcc, 16, v12
    v_mul_u32_u24 v13, 3456, v13
    s_nop 0
    v_cndmask_b32 v12, v12, v14, vcc
    v_cmp_gt_u32 vcc, 9, v12
    v_lshl_add_u32 v13, v12, 4, v13
    s_nop 0
    v_cndmask_b32 v12, v11, v10, vcc
    v_add_u32 v4, v12, v13
    s_add_u32 m0, s29, 16384
    s_nop 0
    buffer_load_dwordx4 v4, s[16:19], s28 offen lds
    v_add_u32 v12, s30, v1
    v_add_u32 v12, 256, v12
    v_mul_u32_u24 v13, 3641, v12
    v_lshrrev_b32 v13, 16, v13
    v_mul_u32_u24 v14, 18, v13
    v_sub_u32 v12, v12, v14
    v_and_b32 v14, 8, v13
    v_xor_b32 v14, v14, v12
    v_cmp_gt_u32 vcc, 16, v12
    v_mul_u32_u24 v13, 3456, v13
    s_nop 0
    v_cndmask_b32 v12, v12, v14, vcc
    v_cmp_gt_u32 vcc, 9, v12
    v_lshl_add_u32 v13, v12, 4, v13
    s_nop 0
    v_cndmask_b32 v12, v11, v10, vcc
    v_add_u32 v5, v12, v13
    s_add_u32 m0, s29, 20480
    s_nop 0
    buffer_load_dwordx4 v5, s[16:19], s28 offen lds
    v_add_u32 v12, s30, v1
    v_add_u32 v12, 512, v12
    v_mul_u32_u24 v13, 3641, v12
    v_lshrrev_b32 v13, 16, v13
    v_mul_u32_u24 v14, 18, v13
    v_sub_u32 v12, v12, v14
    v_and_b32 v14, 8, v13
    v_xor_b32 v14, v14, v12
    v_cmp_gt_u32 vcc, 16, v12
    v_mul_u32_u24 v13, 3456, v13
    s_nop 0
    v_cndmask_b32 v12, v12, v14, vcc
    v_cmp_gt_u32 vcc, 9, v12
    v_lshl_add_u32 v13, v12, 4, v13
    s_nop 0
    v_cndmask_b32 v12, v11, v10, vcc
    v_add_u32 v6, v12, v13
    s_add_u32 m0, s29, 24576
    s_nop 0
    buffer_load_dwordx4 v6, s[16:19], s28 offen lds
    v_add_u32 v12, s30, v1
    v_add_u32 v12, 768, v12
    v_mul_u32_u24 v13, 3641, v12
    v_lshrrev_b32 v13, 16, v13
    v_mul_u32_u24 v14, 18, v13
    v_sub_u32 v12, v12, v14
    v_and_b32 v14, 8, v13
    v_xor_b32 v14, v14, v12
    v_cmp_gt_u32 vcc, 16, v12
    v_mul_u32_u24 v13, 3456, v13
    s_nop 0
    v_cndmask_b32 v12, v12, v14, vcc
    v_cmp_gt_u32 vcc, 9, v12
    v_lshl_add_u32 v13, v12, 4, v13
    s_nop 0
    v_cndmask_b32 v12, v11, v10, vcc
    v_add_u32 v7, v12, v13
    s_add_u32 m0, s29, 28672
    s_nop 0
    buffer_load_dwordx4 v7, s[16:19], s28 offen lds
    v_add_u32 v12, s30, v1
    v_add_u32 v12, 1024, v12
    v_mul_u32_u24 v13, 3641, v12
    v_lshrrev_b32 v13, 16, v13
    v_mul_u32_u24 v14, 18, v13
    v_sub_u32 v12, v12, v14
    v_and_b32 v14, 8, v13
    v_xor_b32 v14, v14, v12
    v_cmp_gt_u32 vcc, 16, v12
    v_mul_u32_u24 v13, 3456, v13
    s_nop 0
    v_cndmask_b32 v12, v12, v14, vcc
    v_cmp_gt_u32 vcc, 9, v12
    v_lshl_add_u32 v13, v12, 4, v13
    s_nop 0
    v_cndmask_b32 v12, v11, v10, vcc
    v_add_u32 v8, v12, v13
    s_cmp_lt_u32 s25, 2
    s_cbranch_scc0 L_ld_kv_lo
    s_add_u32 m0, s29, 32768
    s_nop 0
    buffer_load_dwordx4 v8, s[16:19], s28 offen lds
    s_add_u32 s26, s26, 128
    s_add_u32 s28, s28, 221184
    s_add_u32 s29, s29, 34816
    s_cmp_ge_u32 s29, 104448
    s_cselect_b32 s37, 104448, 0
    s_sub_u32 s29, s29, s37
    s_add_u32 m0, s29, 0
    s_add_u32 s31, s26, 0
    buffer_load_dwordx4 v2, s[12:15], s31 offen lds
    s_add_u32 m0, s29, 4096
    s_add_u32 s31, s26, 36864
    buffer_load_dwordx4 v2, s[12:15], s31 offen lds
    s_add_u32 m0, s29, 8192
    s_add_u32 s31, s26, 73728
    buffer_load_dwordx4 v2, s[12:15], s31 offen lds
    s_add_u32 m0, s29, 12288
    s_add_u32 s31, s26, 110592
    buffer_load_dwordx4 v2, s[12:15], s31 offen lds
    s_add_u32 m0, s29, 16384
    s_nop 0
    buffer_load_dwordx4 v4, s[16:19], s28 offen lds
    s_add_u32 m0, s29, 20480
    s_nop 0
    buffer_load_dwordx4 v5, s[16:19], s28 offen lds
    s_add_u32 m0, s29, 24576
    s_nop 0
    buffer_load_dwordx4 v6, s[16:19], s28 offen lds
    s_add_u32 m0, s29, 28672
    s_nop 0
    buffer_load_dwordx4 v7, s[16:19], s28 offen lds
    s_add_u32 m0, s29, 32768
    s_nop 0
    buffer_load_dwordx4 v8, s[16:19], s28 offen lds
    s_mov_b32 s36, 2
L_ld_kv_hi_loop:
    s_waitcnt vmcnt(9)
    s_barrier
    s_add_u32 s26, s26, 128
    s_add_u32 s28, s28, 221184
    s_add_u32 s29, s29, 34816
    s_cmp_ge_u32 s29, 104448
    s_cselect_b32 s37, 104448, 0
    s_sub_u32 s29, s29, s37
    s_add_u32 m0, s29, 0
    s_add_u32 s31, s26, 0
    buffer_load_dwordx4 v2, s[12:15], s31 offen lds
    s_add_u32 m0, s29, 4096
    s_add_u32 s31, s26, 36864
    buffer_load_dwordx4 v2, s[12:15], s31 offen lds
    s_add_u32 m0, s29, 8192
    s_add_u32 s31, s26, 73728
    buffer_load_dwordx4 v2, s[12:15], s31 offen lds
    s_add_u32 m0, s29, 12288
    s_add_u32 s31, s26, 110592
    buffer_load_dwordx4 v2, s[12:15], s31 offen lds
    s_add_u32 m0, s29, 16384
    s_nop 0
    buffer_load_dwordx4 v4, s[16:19], s28 offen lds
    s_add_u32 m0, s29, 20480
    s_nop 0
    buffer_load_dwordx4 v5, s[16:19], s28 offen lds
    s_add_u32 m0, s29, 24576
    s_nop 0
    buffer_load_dwordx4 v6, s[16:19], s28 offen lds
    s_add_u32 m0, s29, 28672
    s_nop 0
    buffer_load_dwordx4 v7, s[16:19], s28 offen lds
    s_add_u32 m0, s29, 32768
    s_nop 0
    buffer_load_dwordx4 v8, s[16:19], s28 offen lds
    s_add_u32 s36, s36, 1
    s_cmp_lt_u32 s36, 9
    s_cbranch_scc1 L_ld_kv_hi_loop
    s_waitcnt vmcnt(9)
    s_barrier
    s_waitcnt vmcnt(0)
    s_barrier
    s_branch L_ld_kv_done
L_ld_kv_lo:
    s_add_u32 s26, s26, 128
    s_add_u32 s28, s28, 221184
    s_add_u32 s29, s29, 34816
    s_cmp_ge_u32 s29, 104448
    s_cselect_b32 s37, 104448, 0
    s_sub_u32 s29, s29, s37
    s_add_u32 m0, s29, 0
    s_add_u32 s31, s26, 0
    buffer_load_dwordx4 v2, s[12:15], s31 offen lds
    s_add_u32 m0, s29, 4096
    s_add_u32 s31, s26, 36864
    buffer_load_dwordx4 v2, s[12:15], s31 offen lds
    s_add_u32 m0, s29, 8192
    s_add_u32 s31, s26, 73728
    buffer_load_dwordx4 v2, s[12:15], s31 offen lds
    s_add_u32 m0, s29, 12288
    s_add_u32 s31, s26, 110592
    buffer_load_dwordx4 v2, s[12:15], s31 offen lds
    s_add_u32 m0, s29, 16384
    s_nop 0
    buffer_load_dwordx4 v4, s[16:19], s28 offen lds
    s_add_u32 m0, s29, 20480
    s_nop 0
    buffer_load_dwordx4 v5, s[16:19], s28 offen lds
    s_add_u32 m0, s29, 24576
    s_nop 0
    buffer_load_dwordx4 v6, s[16:19], s28 offen lds
    s_add_u32 m0, s29, 28672
    s_nop 0
    buffer_load_dwordx4 v7, s[16:19], s28 offen lds
    s_mov_b32 s36, 2
L_ld_kv_lo_loop:
    s_waitcnt vmcnt(8)
    s_barrier
    s_add_u32 s26, s26, 128
    s_add_u32 s28, s28, 221184
    s_add_u32 s29, s29, 34816
    s_cmp_ge_u32 s29, 104448
    s_cselect_b32 s37, 104448, 0
    s_sub_u32 s29, s29, s37
    s_add_u32 m0, s29, 0
    s_add_u32 s31, s26, 0
    buffer_load_dwordx4 v2, s[12:15], s31 offen lds
    s_add_u32 m0, s29, 4096
    s_add_u32 s31, s26, 36864
    buffer_load_dwordx4 v2, s[12:15], s31 offen lds
    s_add_u32 m0, s29, 8192
    s_add_u32 s31, s26, 73728
    buffer_load_dwordx4 v2, s[12:15], s31 offen lds
    s_add_u32 m0, s29, 12288
    s_add_u32 s31, s26, 110592
    buffer_load_dwordx4 v2, s[12:15], s31 offen lds
    s_add_u32 m0, s29, 16384
    s_nop 0
    buffer_load_dwordx4 v4, s[16:19], s28 offen lds
    s_add_u32 m0, s29, 20480
    s_nop 0
    buffer_load_dwordx4 v5, s[16:19], s28 offen lds
    s_add_u32 m0, s29, 24576
    s_nop 0
    buffer_load_dwordx4 v6, s[16:19], s28 offen lds
    s_add_u32 m0, s29, 28672
    s_nop 0
    buffer_load_dwordx4 v7, s[16:19], s28 offen lds
    s_add_u32 s36, s36, 1
    s_cmp_lt_u32 s36, 9
    s_cbranch_scc1 L_ld_kv_lo_loop
    s_waitcnt vmcnt(8)
    s_barrier
    s_waitcnt vmcnt(0)
    s_barrier
    s_branch L_ld_kv_done
L_ld_kv_done:
    s_barrier
    s_sub_u32 s20, s2, 32
    s_cmp_ge_u32 s2, 128
    s_cselect_b32 s20, s20, s2
    s_cmp_ge_u32 s20, 96
    s_cselect_b32 s21, 1, 0
    s_cmp_ge_u32 s2, 128
    s_cselect_b32 s21, 0, s21
    s_cmp_eq_u32 s21, 1
    s_cbranch_scc1 L_kv_idle
    s_and_b32 s22, s20, 15
    s_lshr_b32 s23, s20, 4
    s_mov_b32 s16, s44
    s_and_b32 s17, s45, 0xffff
    s_mov_b32 s18, 663552
    s_mov_b32 s19, 0x20000
    v_lshrrev_b32 v2, 3, v1
    v_and_b32 v3, 7, v1
    v_and_b32 v4, 3, v2
    v_xor_b32 v3, v3, v4
    v_lshlrev_b32 v3, 4, v3
    v_mul_u32_u24 v2, 1152, v2
    v_add_u32 v2, v2, v3
    s_lshl_b32 s82, s23, 7
    s_sub_u32 s83, s3, 4
L_g2wo_1:
    s_mul_i32 s26, s83, 3641
    s_lshr_b32 s26, s26, 16
    s_add_u32 s26, s26, s83
    s_and_b32 s26, s26, 1
    s_lshl_b32 s26, s26, 6
    v_xor_b32 v3, s26, v2
    s_lshl_b32 m0, s83, 10
    s_mul_i32 s25, s83, 9216
    s_add_u32 s25, s25, s82
    buffer_load_dwordx4 v3, s[16:19], s25 offen lds
    s_add_u32 s83, s83, 4
    s_cmp_lt_u32 s83, 72
    s_cbranch_scc1 L_g2wo_1
    s_barrier
    v_mov_b32 v4, 0
    v_mov_b32 v5, 0
    v_mov_b32 v6, 0
    v_mov_b32 v7, 0
    v_subrev_u32 v12, 256, v0
    v_lshlrev_b32 v13, 4, v12
    v_cmp_gt_u32 vcc, 112, v12
    s_and_saveexec_b64 s[26:27], vcc
    v_add_u32 v11, 73728, v13
    ds_write_b128 v11, v[4:7]
    s_mov_b64 exec, -1
    v_add_u32 v11, 77824, v13
    ds_write_b128 v11, v[4:7] offset:0
    ds_write_b128 v11, v[4:7] offset:4096
    ds_write_b128 v11, v[4:7] offset:8192
    ds_write_b128 v11, v[4:7] offset:12288
    ds_write_b128 v11, v[4:7] offset:16384
    ds_write_b128 v11, v[4:7] offset:20480
    ds_write_b128 v11, v[4:7] offset:24576
    ds_write_b128 v11, v[4:7] offset:28672
    ds_write_b128 v11, v[4:7] offset:32768
    s_movk_i32 s38, 60
    v_cmp_gt_u32 vcc, s38, v12
    s_and_saveexec_b64 s[26:27], vcc
    ds_write_b128 v11, v[4:7] offset:36864
    s_mov_b64 exec, -1
    v_lshlrev_b32 v215, 4, v0
    v_and_b32 v213, 15, v1
    v_lshrrev_b32 v214, 4, v1
    v_lshrrev_b32 v12, 2, v213
    v_and_b32 v13, 3, v213
    v_lshl_add_u32 v13, v12, 3, v13
    v_mul_u32_u24 v13, 288, v13
    v_add_u32 v13, 106144, v13
    v_add_u32 v14, 1152, v13
    v_mov_b32 v15, 115360
    v_cmp_eq_u32 vcc, v12, v214
    s_nop 1
    v_cndmask_b32 v233, v15, v13, vcc
    v_cndmask_b32 v234, v15, v14, vcc
    s_mul_i32 s24, s3, 18
    v_bfe_u32 v12, v1, 2, 2
    v_and_b32 v21, 3, v1
    v_lshl_add_u32 v20, v214, 3, v12
    v_add_u32 v20, s24, v20
    v_lshrrev_b32 v24, 3, v20
    v_and_b32 v24, 1, v24
    v_and_b32 v25, 3, v20
    v_lshl_or_b32 v24, v24, 2, v25
    v_lshrrev_b32 v25, 1, v21
    v_xor_b32 v24, v24, v25
    v_lshlrev_b32 v23, 7, v20
    v_lshl_add_u32 v23, v24, 4, v23
    v_and_b32 v25, 1, v21
    v_lshl_add_u32 v23, v25, 3, v23
    v_xor_b32 v200, 0, v23
    v_xor_b32 v201, 32, v23
    v_xor_b32 v202, 64, v23
    v_xor_b32 v203, 96, v23
    v_add_u32 v20, 4, v20
    v_lshrrev_b32 v24, 3, v20
    v_and_b32 v24, 1, v24
    v_and_b32 v25, 3, v20
    v_lshl_or_b32 v24, v24, 2, v25
    v_lshrrev_b32 v25, 1, v21
    v_xor_b32 v24, v24, v25
    v_lshlrev_b32 v23, 7, v20
    v_lshl_add_u32 v23, v24, 4, v23
    v_and_b32 v25, 1, v21
    v_lshl_add_u32 v23, v25, 3, v23
    v_xor_b32 v204, 0, v23
    v_xor_b32 v205, 32, v23
    v_xor_b32 v206, 64, v23
    v_xor_b32 v207, 96, v23
    v_add_u32 v20, s24, v213
    v_mul_u32_u24 v23, 304, v213
    s_mul_i32 s25, s3, 36
    v_add_u32 v23, s25, v23
    v_lshl_add_u32 v208, v214, 3, v23
    v_add_u32 v209, 4864, v208
    v_add_u32 v210, 9728, v208
    v_add_u32 v211, 14592, v208
    v_mul_u32_u24 v24, 19456, v214
    v_add_u32 v24, v24, v23
    v_add_u32 v212, 32, v24
    v_lshrrev_b32 v24, 2, v213
    v_and_b32 v25, 3, v213
    s_add_u32 s25, s24, 16
    v_mul_u32_u24 v22, 48, v20
    v_lshl_add_u32 v22, v214, 4, v22
    v_add_u32 v22, 77824, v22
    v_mov_b32 v15, 115360
    v_cmp_eq_u32 s[34:35], 3, v214
    v_cmp_gt_u32 s[38:39], 2, v25
    v_add_u32 v23, s25, v25
    v_mul_u32_u24 v23, 48, v23
    v_lshl_add_u32 v23, v214, 4, v23
    v_add_u32 v23, 77824, v23
    s_andn2_b64 s[38:39], s[38:39], s[34:35]
    v_add_u32 v28, 0, v22
    v_cndmask_b32 v216, v28, v15, s[34:35]
    v_cmp_eq_u32 vcc, 0, v24
    v_add_u32 v28, 0, v23
    s_nop 0
    s_and_b64 s[36:37], vcc, s[38:39]
    v_cndmask_b32 v220, v15, v28, s[36:37]
    v_add_u32 v28, 6912, v22
    v_cndmask_b32 v217, v28, v15, s[34:35]
    v_cmp_eq_u32 vcc, 1, v24
    v_add_u32 v28, 6912, v23
    s_nop 0
    s_and_b64 s[36:37], vcc, s[38:39]
    v_cndmask_b32 v221, v15, v28, s[36:37]
    v_add_u32 v28, 13824, v22
    v_cndmask_b32 v218, v28, v15, s[34:35]
    v_cmp_eq_u32 vcc, 2, v24
    v_add_u32 v28, 13824, v23
    s_nop 0
    s_and_b64 s[36:37], vcc, s[38:39]
    v_cndmask_b32 v222, v15, v28, s[36:37]
    v_add_u32 v28, 20736, v22
    v_cndmask_b32 v219, v28, v15, s[34:35]
    v_cmp_eq_u32 vcc, 3, v24
    v_add_u32 v28, 20736, v23
    s_nop 0
    s_and_b64 s[36:37], vcc, s[38:39]
    v_cndmask_b32 v223, v15, v28, s[36:37]
    v_add_u32 v12, 0, v0
    v_mul_u32_u24 v13, 10923, v12
    v_lshrrev_b32 v13, 16, v13
    v_mul_u32_u24 v14, 6, v13
    v_sub_u32 v14, v12, v14
    v_cmp_eq_u32 s[68:69], 5, v14
    v_mul_u32_u24 v14, 3641, v13
    v_lshrrev_b32 v15, 16, v14
    v_lshrrev_b32 v14, 19, v14
    v_mul_u32_u24 v14, 144, v14
    v_sub_u32 v14, v13, v14
    v_mul_u32_u24 v15, 288, v15
    v_lshl_add_u32 v14, v14, 1, v15
    v_add_u32 v14, 106144, v14
    v_lshlrev_b32 v12, 3, v12
    v_add_u32 v12, 77824, v12
    v_cndmask_b32 v224, v12, v14, s[68:69]
    v_add_u32 v12, 512, v0
    v_mul_u32_u24 v13, 10923, v12
    v_lshrrev_b32 v13, 16, v13
    v_mul_u32_u24 v14, 6, v13
    v_sub_u32 v14, v12, v14
    v_cmp_eq_u32 s[70:71], 5, v14
    v_mul_u32_u24 v14, 3641, v13
    v_lshrrev_b32 v15, 16, v14
    v_lshrrev_b32 v14, 19, v14
    v_mul_u32_u24 v14, 144, v14
    v_sub_u32 v14, v13, v14
    v_mul_u32_u24 v15, 288, v15
    v_lshl_add_u32 v14, v14, 1, v15
    v_add_u32 v14, 106144, v14
    v_lshlrev_b32 v12, 3, v12
    v_add_u32 v12, 77824, v12
    v_cndmask_b32 v225, v12, v14, s[70:71]
    v_add_u32 v12, 1024, v0
    v_mul_u32_u24 v13, 10923, v12
    v_lshrrev_b32 v13, 16, v13
    v_mul_u32_u24 v14, 6, v13
    v_sub_u32 v14, v12, v14
    v_cmp_eq_u32 s[72:73], 5, v14
    v_mul_u32_u24 v14, 3641, v13
    v_lshrrev_b32 v15, 16, v14
    v_lshrrev_b32 v14, 19, v14
    v_mul_u32_u24 v14, 144, v14
    v_sub_u32 v14, v13, v14
    v_mul_u32_u24 v15, 288, v15
    v_lshl_add_u32 v14, v14, 1, v15
    v_add_u32 v14, 106144, v14
    v_lshlrev_b32 v12, 3, v12
    v_add_u32 v12, 77824, v12
    v_cndmask_b32 v226, v12, v14, s[72:73]
    v_add_u32 v12, 1536, v0
    v_mul_u32_u24 v13, 10923, v12
    v_lshrrev_b32 v13, 16, v13
    v_mul_u32_u24 v14, 6, v13
    v_sub_u32 v14, v12, v14
    v_cmp_eq_u32 s[74:75], 5, v14
    v_mul_u32_u24 v14, 3641, v13
    v_lshrrev_b32 v15, 16, v14
    v_lshrrev_b32 v14, 19, v14
    v_mul_u32_u24 v14, 144, v14
    v_sub_u32 v14, v13, v14
    v_mul_u32_u24 v15, 288, v15
    v_lshl_add_u32 v14, v14, 1, v15
    v_add_u32 v14, 106144, v14
    v_lshlrev_b32 v12, 3, v12
    v_add_u32 v12, 77824, v12
    v_cndmask_b32 v227, v12, v14, s[74:75]
    v_add_u32 v12, 2048, v0
    v_mul_u32_u24 v13, 10923, v12
    v_lshrrev_b32 v13, 16, v13
    v_mul_u32_u24 v14, 6, v13
    v_sub_u32 v14, v12, v14
    v_cmp_eq_u32 s[76:77], 5, v14
    v_mul_u32_u24 v14, 3641, v13
    v_lshrrev_b32 v15, 16, v14
    v_lshrrev_b32 v14, 19, v14
    v_mul_u32_u24 v14, 144, v14
    v_sub_u32 v14, v13, v14
    v_mul_u32_u24 v15, 288, v15
    v_lshl_add_u32 v14, v14, 1, v15
    v_add_u32 v14, 106144, v14
    v_lshlrev_b32 v12, 3, v12
    v_add_u32 v12, 77824, v12
    v_cndmask_b32 v228, v12, v14, s[76:77]
    v_add_u32 v12, 2560, v0
    v_mul_u32_u24 v13, 10923, v12
    v_lshrrev_b32 v13, 16, v13
    v_mul_u32_u24 v14, 6, v13
    v_sub_u32 v14, v12, v14
    v_cmp_eq_u32 s[78:79], 5, v14
    v_mul_u32_u24 v14, 3641, v13
    v_lshrrev_b32 v15, 16, v14
    v_lshrrev_b32 v14, 19, v14
    v_mul_u32_u24 v14, 144, v14
    v_sub_u32 v14, v13, v14
    v_mul_u32_u24 v15, 288, v15
    v_lshl_add_u32 v14, v14, 1, v15
    v_add_u32 v14, 106144, v14
    v_lshlrev_b32 v12, 3, v12
    v_add_u32 v12, 77824, v12
    v_cndmask_b32 v229, v12, v14, s[78:79]
    v_add_u32 v12, 3072, v0
    v_mul_u32_u24 v13, 10923, v12
    v_lshrrev_b32 v13, 16, v13
    v_mul_u32_u24 v14, 6, v13
    v_sub_u32 v14, v12, v14
    v_cmp_eq_u32 s[80:81], 5, v14
    v_mul_u32_u24 v14, 3641, v13
    v_lshrrev_b32 v15, 16, v14
    v_lshrrev_b32 v14, 19, v14
    v_mul_u32_u24 v14, 144, v14
    v_sub_u32 v14, v13, v14
    v_mul_u32_u24 v15, 288, v15
    v_lshl_add_u32 v14, v14, 1, v15
    v_add_u32 v14, 106144, v14
    v_lshlrev_b32 v12, 3, v12
    v_add_u32 v12, 77824, v12
    v_cndmask_b32 v230, v12, v14, s[80:81]
    v_mul_u32_u24 v12, 304, v213
    v_mul_u32_u24 v13, 19456, v214
    v_add_u32 v235, v12, v13
    s_barrier
    s_waitcnt vmcnt(0)
    s_branch L_A_post
L_kv_idle:
    s_barrier
    s_barrier
    s_endpgm
L_g1kv_compute:
    v_lshlrev_b32 v215, 4, v0
    v_and_b32 v213, 15, v1
    v_lshrrev_b32 v214, 4, v1
    v_lshrrev_b32 v12, 2, v213
    v_and_b32 v13, 3, v213
    v_lshl_add_u32 v13, v12, 3, v13
    v_mul_u32_u24 v13, 288, v13
    v_add_u32 v13, 106144, v13
    v_add_u32 v14, 1152, v13
    v_mov_b32 v15, 115360
    v_cmp_eq_u32 vcc, v12, v214
    s_nop 1
    v_cndmask_b32 v233, v15, v13, vcc
    v_cndmask_b32 v234, v15, v14, vcc
    s_mul_i32 s24, s3, 18
    v_bfe_u32 v12, v1, 2, 2
    v_and_b32 v21, 3, v1
    v_lshl_add_u32 v20, v214, 3, v12
    v_add_u32 v20, s24, v20
    v_lshrrev_b32 v24, 3, v20
    v_and_b32 v24, 1, v24
    v_and_b32 v25, 3, v20
    v_lshl_or_b32 v24, v24, 2, v25
    v_lshrrev_b32 v25, 1, v21
    v_xor_b32 v24, v24, v25
    v_lshlrev_b32 v23, 7, v20
    v_lshl_add_u32 v23, v24, 4, v23
    v_and_b32 v25, 1, v21
    v_lshl_add_u32 v23, v25, 3, v23
    v_xor_b32 v200, 0, v23
    v_xor_b32 v201, 32, v23
    v_xor_b32 v202, 64, v23
    v_xor_b32 v203, 96, v23
    v_add_u32 v20, 4, v20
    v_lshrrev_b32 v24, 3, v20
    v_and_b32 v24, 1, v24
    v_and_b32 v25, 3, v20
    v_lshl_or_b32 v24, v24, 2, v25
    v_lshrrev_b32 v25, 1, v21
    v_xor_b32 v24, v24, v25
    v_lshlrev_b32 v23, 7, v20
    v_lshl_add_u32 v23, v24, 4, v23
    v_and_b32 v25, 1, v21
    v_lshl_add_u32 v23, v25, 3, v23
    v_xor_b32 v204, 0, v23
    v_xor_b32 v205, 32, v23
    v_xor_b32 v206, 64, v23
    v_xor_b32 v207, 96, v23
    v_add_u32 v20, s24, v213
    v_mul_u32_u24 v23, 304, v213
    s_mul_i32 s25, s3, 36
    v_add_u32 v23, s25, v23
    v_lshl_add_u32 v208, v214, 3, v23
    v_add_u32 v209, 4864, v208
    v_add_u32 v210, 9728, v208
    v_add_u32 v211, 14592, v208
    v_mul_u32_u24 v24, 19456, v214
    v_add_u32 v24, v24, v23
    v_add_u32 v212, 32, v24
    v_lshrrev_b32 v24, 2, v213
    v_and_b32 v25, 3, v213
    s_add_u32 s25, s24, 16
    v_mul_u32_u24 v22, 48, v20
    v_lshl_add_u32 v22, v214, 4, v22
    v_add_u32 v22, 77824, v22
    v_mov_b32 v15, 115360
    v_cmp_eq_u32 s[34:35], 3, v214
    v_cmp_gt_u32 s[38:39], 2, v25
    v_add_u32 v23, s25, v25
    v_mul_u32_u24 v23, 48, v23
    v_lshl_add_u32 v23, v214, 4, v23
    v_add_u32 v23, 77824, v23
    s_andn2_b64 s[38:39], s[38:39], s[34:35]
    v_add_u32 v28, 0, v22
    v_cndmask_b32 v216, v28, v15, s[34:35]
    v_cmp_eq_u32 vcc, 0, v24
    v_add_u32 v28, 0, v23
    s_nop 0
    s_and_b64 s[36:37], vcc, s[38:39]
    v_cndmask_b32 v220, v15, v28, s[36:37]
    v_add_u32 v28, 6912, v22
    v_cndmask_b32 v217, v28, v15, s[34:35]
    v_cmp_eq_u32 vcc, 1, v24
    v_add_u32 v28, 6912, v23
    s_nop 0
    s_and_b64 s[36:37], vcc, s[38:39]
    v_cndmask_b32 v221, v15, v28, s[36:37]
    v_add_u32 v28, 13824, v22
    v_cndmask_b32 v218, v28, v15, s[34:35]
    v_cmp_eq_u32 vcc, 2, v24
    v_add_u32 v28, 13824, v23
    s_nop 0
    s_and_b64 s[36:37], vcc, s[38:39]
    v_cndmask_b32 v222, v15, v28, s[36:37]
    v_add_u32 v28, 20736, v22
    v_cndmask_b32 v219, v28, v15, s[34:35]
    v_cmp_eq_u32 vcc, 3, v24
    v_add_u32 v28, 20736, v23
    s_nop 0
    s_and_b64 s[36:37], vcc, s[38:39]
    v_cndmask_b32 v223, v15, v28, s[36:37]
    v_add_u32 v12, 0, v0
    v_mul_u32_u24 v13, 10923, v12
    v_lshrrev_b32 v13, 16, v13
    v_mul_u32_u24 v14, 6, v13
    v_sub_u32 v14, v12, v14
    v_cmp_eq_u32 s[68:69], 5, v14
    v_mul_u32_u24 v14, 3641, v13
    v_lshrrev_b32 v15, 16, v14
    v_lshrrev_b32 v14, 19, v14
    v_mul_u32_u24 v14, 144, v14
    v_sub_u32 v14, v13, v14
    v_mul_u32_u24 v15, 288, v15
    v_lshl_add_u32 v14, v14, 1, v15
    v_add_u32 v14, 106144, v14
    v_lshlrev_b32 v12, 3, v12
    v_add_u32 v12, 77824, v12
    v_cndmask_b32 v224, v12, v14, s[68:69]
    v_add_u32 v12, 512, v0
    v_mul_u32_u24 v13, 10923, v12
    v_lshrrev_b32 v13, 16, v13
    v_mul_u32_u24 v14, 6, v13
    v_sub_u32 v14, v12, v14
    v_cmp_eq_u32 s[70:71], 5, v14
    v_mul_u32_u24 v14, 3641, v13
    v_lshrrev_b32 v15, 16, v14
    v_lshrrev_b32 v14, 19, v14
    v_mul_u32_u24 v14, 144, v14
    v_sub_u32 v14, v13, v14
    v_mul_u32_u24 v15, 288, v15
    v_lshl_add_u32 v14, v14, 1, v15
    v_add_u32 v14, 106144, v14
    v_lshlrev_b32 v12, 3, v12
    v_add_u32 v12, 77824, v12
    v_cndmask_b32 v225, v12, v14, s[70:71]
    v_add_u32 v12, 1024, v0
    v_mul_u32_u24 v13, 10923, v12
    v_lshrrev_b32 v13, 16, v13
    v_mul_u32_u24 v14, 6, v13
    v_sub_u32 v14, v12, v14
    v_cmp_eq_u32 s[72:73], 5, v14
    v_mul_u32_u24 v14, 3641, v13
    v_lshrrev_b32 v15, 16, v14
    v_lshrrev_b32 v14, 19, v14
    v_mul_u32_u24 v14, 144, v14
    v_sub_u32 v14, v13, v14
    v_mul_u32_u24 v15, 288, v15
    v_lshl_add_u32 v14, v14, 1, v15
    v_add_u32 v14, 106144, v14
    v_lshlrev_b32 v12, 3, v12
    v_add_u32 v12, 77824, v12
    v_cndmask_b32 v226, v12, v14, s[72:73]
    v_add_u32 v12, 1536, v0
    v_mul_u32_u24 v13, 10923, v12
    v_lshrrev_b32 v13, 16, v13
    v_mul_u32_u24 v14, 6, v13
    v_sub_u32 v14, v12, v14
    v_cmp_eq_u32 s[74:75], 5, v14
    v_mul_u32_u24 v14, 3641, v13
    v_lshrrev_b32 v15, 16, v14
    v_lshrrev_b32 v14, 19, v14
    v_mul_u32_u24 v14, 144, v14
    v_sub_u32 v14, v13, v14
    v_mul_u32_u24 v15, 288, v15
    v_lshl_add_u32 v14, v14, 1, v15
    v_add_u32 v14, 106144, v14
    v_lshlrev_b32 v12, 3, v12
    v_add_u32 v12, 77824, v12
    v_cndmask_b32 v227, v12, v14, s[74:75]
    v_add_u32 v12, 2048, v0
    v_mul_u32_u24 v13, 10923, v12
    v_lshrrev_b32 v13, 16, v13
    v_mul_u32_u24 v14, 6, v13
    v_sub_u32 v14, v12, v14
    v_cmp_eq_u32 s[76:77], 5, v14
    v_mul_u32_u24 v14, 3641, v13
    v_lshrrev_b32 v15, 16, v14
    v_lshrrev_b32 v14, 19, v14
    v_mul_u32_u24 v14, 144, v14
    v_sub_u32 v14, v13, v14
    v_mul_u32_u24 v15, 288, v15
    v_lshl_add_u32 v14, v14, 1, v15
    v_add_u32 v14, 106144, v14
    v_lshlrev_b32 v12, 3, v12
    v_add_u32 v12, 77824, v12
    v_cndmask_b32 v228, v12, v14, s[76:77]
    v_add_u32 v12, 2560, v0
    v_mul_u32_u24 v13, 10923, v12
    v_lshrrev_b32 v13, 16, v13
    v_mul_u32_u24 v14, 6, v13
    v_sub_u32 v14, v12, v14
    v_cmp_eq_u32 s[78:79], 5, v14
    v_mul_u32_u24 v14, 3641, v13
    v_lshrrev_b32 v15, 16, v14
    v_lshrrev_b32 v14, 19, v14
    v_mul_u32_u24 v14, 144, v14
    v_sub_u32 v14, v13, v14
    v_mul_u32_u24 v15, 288, v15
    v_lshl_add_u32 v14, v14, 1, v15
    v_add_u32 v14, 106144, v14
    v_lshlrev_b32 v12, 3, v12
    v_add_u32 v12, 77824, v12
    v_cndmask_b32 v229, v12, v14, s[78:79]
    v_add_u32 v12, 3072, v0
    v_mul_u32_u24 v13, 10923, v12
    v_lshrrev_b32 v13, 16, v13
    v_mul_u32_u24 v14, 6, v13
    v_sub_u32 v14, v12, v14
    v_cmp_eq_u32 s[80:81], 5, v14
    v_mul_u32_u24 v14, 3641, v13
    v_lshrrev_b32 v15, 16, v14
    v_lshrrev_b32 v14, 19, v14
    v_mul_u32_u24 v14, 144, v14
    v_sub_u32 v14, v13, v14
    v_mul_u32_u24 v15, 288, v15
    v_lshl_add_u32 v14, v14, 1, v15
    v_add_u32 v14, 106144, v14
    v_lshlrev_b32 v12, 3, v12
    v_add_u32 v12, 77824, v12
    v_cndmask_b32 v230, v12, v14, s[80:81]
    v_mul_u32_u24 v12, 304, v213
    v_mul_u32_u24 v13, 19456, v214
    v_add_u32 v235, v12, v13
    v_and_b32 v2, 15, v1
    v_lshrrev_b32 v3, 4, v1
    s_lshl_b32 s24, s3, 12
    v_and_b32 v4, 7, v2
    v_xor_b32 v4, v4, v3
    v_lshlrev_b32 v5, 7, v2
    v_lshl_add_u32 v5, v4, 4, v5
    v_add_u32 v6, s24, v5
    v_xor_b32 v7, 64, v6
    v_bfe_u32 v4, v1, 2, 2
    v_lshl_add_u32 v5, v3, 3, v4
    v_mul_u32_u24 v5, 288, v5
    v_and_b32 v8, 3, v1
    v_lshl_add_u32 v5, v8, 3, v5
    v_add_u32 v5, 16384, v5
    v_and_b32 v4, 1, v3
    v_lshlrev_b32 v4, 7, v4
    v_add_u32 v8, v5, v4
    v_sub_u32 v9, v5, v4
    v_mov_b32 v10, v5
    v_mov_b32 v64, 0
    v_mov_b32 v65, 0
    v_mov_b32 v66, 0
    v_mov_b32 v67, 0
    v_mov_b32 v68, 0
    v_mov_b32 v69, 0
    v_mov_b32 v70, 0
    v_mov_b32 v71, 0
    v_mov_b32 v72, 0
    v_mov_b32 v73, 0
    v_mov_b32 v74, 0
    v_mov_b32 v75, 0
    v_mov_b32 v76, 0
    v_mov_b32 v77, 0
    v_mov_b32 v78, 0
    v_mov_b32 v79, 0
    v_mov_b32 v80, 0
    v_mov_b32 v81, 0
    v_mov_b32 v82, 0
    v_mov_b32 v83, 0
    v_mov_b32 v84, 0
    v_mov_b32 v85, 0
    v_mov_b32 v86, 0
    v_mov_b32 v87, 0
    v_mov_b32 v88, 0
    v_mov_b32 v89, 0
    v_mov_b32 v90, 0
    v_mov_b32 v91, 0
    v_mov_b32 v92, 0
    v_mov_b32 v93, 0
    v_mov_b32 v94, 0
    v_mov_b32 v95, 0
    v_mov_b32 v96, 0
    v_mov_b32 v97, 0
    v_mov_b32 v98, 0
    v_mov_b32 v99, 0
    v_mov_b32 v100, 0
    v_mov_b32 v101, 0
    v_mov_b32 v102, 0
    v_mov_b32 v103, 0
    v_mov_b32 v104, 0
    v_mov_b32 v105, 0
    v_mov_b32 v106, 0
    v_mov_b32 v107, 0
    v_mov_b32 v108, 0
    v_mov_b32 v109, 0
    v_mov_b32 v110, 0
    v_mov_b32 v111, 0
    v_mov_b32 v112, 0
    v_mov_b32 v113, 0
    v_mov_b32 v114, 0
    v_mov_b32 v115, 0
    v_mov_b32 v116, 0
    v_mov_b32 v117, 0
    v_mov_b32 v118, 0
    v_mov_b32 v119, 0
    v_mov_b32 v120, 0
    v_mov_b32 v121, 0
    v_mov_b32 v122, 0
    v_mov_b32 v123, 0
    v_mov_b32 v124, 0
    v_mov_b32 v125, 0
    v_mov_b32 v126, 0
    v_mov_b32 v127, 0
    v_mov_b32 v128, 0
    v_mov_b32 v129, 0
    v_mov_b32 v130, 0
    v_mov_b32 v131, 0
    v_mov_b32 v132, 0
    v_mov_b32 v133, 0
    v_mov_b32 v134, 0
    v_mov_b32 v135, 0
    s_mov_b32 s24, 0
    s_mov_b32 s25, 0
    v_mov_b32 v12, v6
    v_mov_b32 v13, v7
    v_mov_b32 v236, v8
    v_mov_b32 v237, v9
    v_mov_b32 v238, v10
L_g1kv_loop:
    s_barrier
    ds_read_b128 v[16:19], v12 offset:0
    ds_read_b64_tr_b16 v[44:45], v236 offset:0
    ds_read_b64_tr_b16 v[46:47], v236 offset:1152
    ds_read_b128 v[20:23], v12 offset:2048
    ds_read_b64_tr_b16 v[48:49], v236 offset:32
    ds_read_b64_tr_b16 v[50:51], v236 offset:1184
    ds_read_b64_tr_b16 v[52:53], v236 offset:64
    ds_read_b64_tr_b16 v[54:55], v236 offset:1216
    ds_read_b64_tr_b16 v[32:33], v236 offset:96
    ds_read_b64_tr_b16 v[34:35], v236 offset:1248
    s_waitcnt lgkmcnt(7)
    v_mfma_f32_16x16x32_bf16 v[64:67], v[16:19], v[44:47], v[64:67]
    s_waitcnt lgkmcnt(6)
    v_mfma_f32_16x16x32_bf16 v[100:103], v[20:23], v[44:47], v[100:103]
    ds_read_b64_tr_b16 v[36:37], v237 offset:128
    ds_read_b64_tr_b16 v[38:39], v237 offset:1280
    s_waitcnt lgkmcnt(6)
    v_mfma_f32_16x16x32_bf16 v[68:71], v[16:19], v[48:51], v[68:71]
    v_mfma_f32_16x16x32_bf16 v[104:107], v[20:23], v[48:51], v[104:107]
    ds_read_b64_tr_b16 v[40:41], v237 offset:160
    ds_read_b64_tr_b16 v[42:43], v237 offset:1312
    ds_read_b128 v[24:27], v13 offset:0
    s_waitcnt lgkmcnt(7)
    v_mfma_f32_16x16x32_bf16 v[72:75], v[16:19], v[52:55], v[72:75]
    v_mfma_f32_16x16x32_bf16 v[108:111], v[20:23], v[52:55], v[108:111]
    ds_read_b64_tr_b16 v[44:45], v237 offset:192
    ds_read_b64_tr_b16 v[46:47], v237 offset:1344
    ds_read_b128 v[28:31], v13 offset:2048
    s_waitcnt lgkmcnt(8)
    v_mfma_f32_16x16x32_bf16 v[76:79], v[16:19], v[32:35], v[76:79]
    v_mfma_f32_16x16x32_bf16 v[112:115], v[20:23], v[32:35], v[112:115]
    ds_read_b64_tr_b16 v[48:49], v237 offset:224
    ds_read_b64_tr_b16 v[50:51], v237 offset:1376
    s_waitcnt lgkmcnt(8)
    v_mfma_f32_16x16x32_bf16 v[80:83], v[16:19], v[36:39], v[80:83]
    v_mfma_f32_16x16x32_bf16 v[116:119], v[20:23], v[36:39], v[116:119]
    ds_read_b64_tr_b16 v[52:53], v238 offset:256
    ds_read_b64_tr_b16 v[54:55], v238 offset:1408
    s_waitcnt lgkmcnt(8)
    v_mfma_f32_16x16x32_bf16 v[84:87], v[16:19], v[40:43], v[84:87]
    v_mfma_f32_16x16x32_bf16 v[120:123], v[20:23], v[40:43], v[120:123]
    ds_read_b64_tr_b16 v[32:33], v236 offset:9216
    ds_read_b64_tr_b16 v[34:35], v236 offset:10368
    s_waitcnt lgkmcnt(7)
    v_mfma_f32_16x16x32_bf16 v[88:91], v[16:19], v[44:47], v[88:91]
    v_mfma_f32_16x16x32_bf16 v[124:127], v[20:23], v[44:47], v[124:127]
    ds_read_b64_tr_b16 v[36:37], v236 offset:9248
    ds_read_b64_tr_b16 v[38:39], v236 offset:10400
    s_waitcnt lgkmcnt(6)
    v_mfma_f32_16x16x32_bf16 v[92:95], v[16:19], v[48:51], v[92:95]
    v_mfma_f32_16x16x32_bf16 v[128:131], v[20:23], v[48:51], v[128:131]
    ds_read_b64_tr_b16 v[40:41], v236 offset:9280
    ds_read_b64_tr_b16 v[42:43], v236 offset:10432
    s_waitcnt lgkmcnt(6)
    v_mfma_f32_16x16x32_bf16 v[96:99], v[16:19], v[52:55], v[96:99]
    v_mfma_f32_16x16x32_bf16 v[132:135], v[20:23], v[52:55], v[132:135]
    ds_read_b64_tr_b16 v[44:45], v236 offset:9312
    ds_read_b64_tr_b16 v[46:47], v236 offset:10464
    s_waitcnt lgkmcnt(6)
    v_mfma_f32_16x16x32_bf16 v[64:67], v[24:27], v[32:35], v[64:67]
    v_mfma_f32_16x16x32_bf16 v[100:103], v[28:31], v[32:35], v[100:103]
    ds_read_b64_tr_b16 v[48:49], v237 offset:9344
    ds_read_b64_tr_b16 v[50:51], v237 offset:10496
    s_waitcnt lgkmcnt(6)
    v_mfma_f32_16x16x32_bf16 v[68:71], v[24:27], v[36:39], v[68:71]
    v_mfma_f32_16x16x32_bf16 v[104:107], v[28:31], v[36:39], v[104:107]
    ds_read_b64_tr_b16 v[52:53], v237 offset:9376
    ds_read_b64_tr_b16 v[54:55], v237 offset:10528
    s_waitcnt lgkmcnt(6)
    v_mfma_f32_16x16x32_bf16 v[72:75], v[24:27], v[40:43], v[72:75]
    v_mfma_f32_16x16x32_bf16 v[108:111], v[28:31], v[40:43], v[108:111]
    ds_read_b64_tr_b16 v[32:33], v237 offset:9408
    ds_read_b64_tr_b16 v[34:35], v237 offset:10560
    s_waitcnt lgkmcnt(6)
    v_mfma_f32_16x16x32_bf16 v[76:79], v[24:27], v[44:47], v[76:79]
    v_mfma_f32_16x16x32_bf16 v[112:115], v[28:31], v[44:47], v[112:115]
    ds_read_b64_tr_b16 v[36:37], v237 offset:9440
    ds_read_b64_tr_b16 v[38:39], v237 offset:10592
    s_waitcnt lgkmcnt(6)
    v_mfma_f32_16x16x32_bf16 v[80:83], v[24:27], v[48:51], v[80:83]
    v_mfma_f32_16x16x32_bf16 v[116:119], v[28:31], v[48:51], v[116:119]
    ds_read_b64_tr_b16 v[40:41], v238 offset:9472
    ds_read_b64_tr_b16 v[42:43], v238 offset:10624
    s_waitcnt lgkmcnt(6)
    v_mfma_f32_16x16x32_bf16 v[84:87], v[24:27], v[52:55], v[84:87]
    v_mfma_f32_16x16x32_bf16 v[120:123], v[28:31], v[52:55], v[120:123]
    s_waitcnt lgkmcnt(4)
    v_mfma_f32_16x16x32_bf16 v[88:91], v[24:27], v[32:35], v[88:91]
    v_mfma_f32_16x16x32_bf16 v[124:127], v[28:31], v[32:35], v[124:127]
    s_waitcnt lgkmcnt(2)
    v_mfma_f32_16x16x32_bf16 v[92:95], v[24:27], v[36:39], v[92:95]
    v_mfma_f32_16x16x32_bf16 v[128:131], v[28:31], v[36:39], v[128:131]
    s_waitcnt lgkmcnt(0)
    v_mfma_f32_16x16x32_bf16 v[96:99], v[24:27], v[40:43], v[96:99]
    v_mfma_f32_16x16x32_bf16 v[132:135], v[28:31], v[40:43], v[132:135]
    s_add_u32 s25, s25, 34816
    s_cmp_ge_u32 s25, 104448
    s_cselect_b32 s37, 104448, 0
    s_sub_u32 s25, s25, s37
    v_add_u32 v12, s25, v6
    v_add_u32 v13, s25, v7
    v_add_u32 v236, s25, v8
    v_add_u32 v237, s25, v9
    v_add_u32 v238, s25, v10
    s_add_u32 s24, s24, 1
    s_cmp_lt_u32 s24, 9
    s_cbranch_scc1 L_g1kv_loop
    v_mov_b32 v16, 0x3fb8aa3b
    v_mov_b32 v17, 0x3fb8aa3b
    v_mov_b32 v18, 0x3f800008
    v_mov_b32 v19, 0x3f800008
    v_mov_b32 v20, 0x358637bd
    v_mov_b32 v21, 0x358637bd
    v_mov_b32 v5, 0
    global_load_dword v60, v5, s[60:61] sc0 sc1
    s_barrier
    v_mul_u32_u24 v4, 272, v2
    v_lshl_add_u32 v4, v3, 3, v4
    s_lshl_b32 s24, s3, 6
    s_add_u32 s24, s24, 116736
    v_add_u32 v4, s24, v4
    v_mov_b32 v6, 0x3f803f80
    v_lshlrev_b32 v7, 2, v1
    v_add_u32 v7, 116736, v7
    ds_write_b32 v7, v6 offset:43520
    v_cmp_gt_u32 s[26:27], 8, v2
    v_cvt_pk_bf16_f32 v36, v84, v85
    v_cvt_pk_bf16_f32 v37, v86, v87
    ds_write_b64 v4, v[36:37] offset:21760
    v_cvt_pk_bf16_f32 v38, v120, v121
    v_cvt_pk_bf16_f32 v39, v122, v123
    ds_write_b64 v4, v[38:39] offset:21792
    v_cvt_pk_bf16_f32 v40, v88, v89
    v_cvt_pk_bf16_f32 v41, v90, v91
    ds_write_b64 v4, v[40:41] offset:26112
    v_cvt_pk_bf16_f32 v42, v124, v125
    v_cvt_pk_bf16_f32 v43, v126, v127
    ds_write_b64 v4, v[42:43] offset:26144
    v_cvt_pk_bf16_f32 v44, v92, v93
    v_cvt_pk_bf16_f32 v45, v94, v95
    ds_write_b64 v4, v[44:45] offset:30464
    v_cvt_pk_bf16_f32 v46, v128, v129
    v_cvt_pk_bf16_f32 v47, v130, v131
    ds_write_b64 v4, v[46:47] offset:30496
    v_cvt_pk_bf16_f32 v32, v96, v97
    v_cvt_pk_bf16_f32 v33, v98, v99
    ds_write_b64 v4, v[32:33] offset:34816
    v_cvt_pk_bf16_f32 v34, v132, v133
    v_cvt_pk_bf16_f32 v35, v134, v135
    ds_write_b64 v4, v[34:35] offset:34848
    v_pk_mul_f32 v[24:25], v[64:65], v[16:17]
    v_pk_mul_f32 v[26:27], v[66:67], v[16:17]
    v_pk_mul_f32 v[28:29], v[100:101], v[16:17]
    v_pk_mul_f32 v[30:31], v[102:103], v[16:17]
    v_pk_add_f32 v[64:65], v[64:65], v[18:19]
    v_pk_add_f32 v[66:67], v[66:67], v[18:19]
    v_exp_f32_e64 v24, v24 clamp
    v_exp_f32_e64 v25, v25 clamp
    v_exp_f32_e64 v26, v26 clamp
    v_exp_f32_e64 v27, v27 clamp
    v_pk_add_f32 v[100:101], v[100:101], v[18:19]
    v_pk_add_f32 v[102:103], v[102:103], v[18:19]
    v_exp_f32_e64 v28, v28 clamp
    v_exp_f32_e64 v29, v29 clamp
    v_exp_f32_e64 v30, v30 clamp
    v_exp_f32_e64 v31, v31 clamp
    v_pk_add_f32 v[24:25], v[24:25], v[20:21]
    v_pk_add_f32 v[26:27], v[26:27], v[20:21]
    v_max_f32 v64, v64, v24
    v_max_f32 v65, v65, v25
    v_pk_add_f32 v[28:29], v[28:29], v[20:21]
    v_pk_add_f32 v[30:31], v[30:31], v[20:21]
    v_max_f32 v66, v66, v26
    v_max_f32 v67, v67, v27
    v_max_f32 v100, v100, v28
    v_max_f32 v101, v101, v29
    v_max_f32 v102, v102, v30
    v_max_f32 v103, v103, v31
    v_cvt_pk_bf16_f32 v32, v64, v65
    v_cvt_pk_bf16_f32 v33, v66, v67
    ds_write_b64 v4, v[32:33] offset:0
    v_cvt_pk_bf16_f32 v34, v100, v101
    v_cvt_pk_bf16_f32 v35, v102, v103
    ds_write_b64 v4, v[34:35] offset:32
    v_pk_mul_f32 v[24:25], v[68:69], v[16:17]
    v_pk_mul_f32 v[26:27], v[70:71], v[16:17]
    v_pk_mul_f32 v[28:29], v[104:105], v[16:17]
    v_pk_mul_f32 v[30:31], v[106:107], v[16:17]
    v_pk_add_f32 v[68:69], v[68:69], v[18:19]
    v_pk_add_f32 v[70:71], v[70:71], v[18:19]
    v_exp_f32_e64 v24, v24 clamp
    v_exp_f32_e64 v25, v25 clamp
    v_exp_f32_e64 v26, v26 clamp
    v_exp_f32_e64 v27, v27 clamp
    v_pk_add_f32 v[104:105], v[104:105], v[18:19]
    v_pk_add_f32 v[106:107], v[106:107], v[18:19]
    v_exp_f32_e64 v28, v28 clamp
    v_exp_f32_e64 v29, v29 clamp
    v_exp_f32_e64 v30, v30 clamp
    v_exp_f32_e64 v31, v31 clamp
    v_pk_add_f32 v[24:25], v[24:25], v[20:21]
    v_pk_add_f32 v[26:27], v[26:27], v[20:21]
    v_max_f32 v68, v68, v24
    v_max_f32 v69, v69, v25
    v_pk_add_f32 v[28:29], v[28:29], v[20:21]
    v_pk_add_f32 v[30:31], v[30:31], v[20:21]
    v_max_f32 v70, v70, v26
    v_max_f32 v71, v71, v27
    v_max_f32 v104, v104, v28
    v_max_f32 v105, v105, v29
    v_max_f32 v106, v106, v30
    v_max_f32 v107, v107, v31
    v_cvt_pk_bf16_f32 v36, v68, v69
    v_cvt_pk_bf16_f32 v37, v70, v71
    ds_write_b64 v4, v[36:37] offset:4352
    v_cvt_pk_bf16_f32 v38, v104, v105
    v_cvt_pk_bf16_f32 v39, v106, v107
    ds_write_b64 v4, v[38:39] offset:4384
    v_pk_mul_f32 v[24:25], v[72:73], v[16:17]
    v_pk_mul_f32 v[26:27], v[74:75], v[16:17]
    v_pk_mul_f32 v[28:29], v[108:109], v[16:17]
    v_pk_mul_f32 v[30:31], v[110:111], v[16:17]
    v_pk_add_f32 v[72:73], v[72:73], v[18:19]
    v_pk_add_f32 v[74:75], v[74:75], v[18:19]
    v_exp_f32_e64 v24, v24 clamp
    v_exp_f32_e64 v25, v25 clamp
    v_exp_f32_e64 v26, v26 clamp
    v_exp_f32_e64 v27, v27 clamp
    v_pk_add_f32 v[108:109], v[108:109], v[18:19]
    v_pk_add_f32 v[110:111], v[110:111], v[18:19]
    v_exp_f32_e64 v28, v28 clamp
    v_exp_f32_e64 v29, v29 clamp
    v_exp_f32_e64 v30, v30 clamp
    v_exp_f32_e64 v31, v31 clamp
    v_pk_add_f32 v[24:25], v[24:25], v[20:21]
    v_pk_add_f32 v[26:27], v[26:27], v[20:21]
    v_max_f32 v72, v72, v24
    v_max_f32 v73, v73, v25
    v_pk_add_f32 v[28:29], v[28:29], v[20:21]
    v_pk_add_f32 v[30:31], v[30:31], v[20:21]
    v_max_f32 v74, v74, v26
    v_max_f32 v75, v75, v27
    v_max_f32 v108, v108, v28
    v_max_f32 v109, v109, v29
    v_max_f32 v110, v110, v30
    v_max_f32 v111, v111, v31
    v_cvt_pk_bf16_f32 v40, v72, v73
    v_cvt_pk_bf16_f32 v41, v74, v75
    ds_write_b64 v4, v[40:41] offset:8704
    v_cvt_pk_bf16_f32 v42, v108, v109
    v_cvt_pk_bf16_f32 v43, v110, v111
    ds_write_b64 v4, v[42:43] offset:8736
    v_pk_mul_f32 v[24:25], v[76:77], v[16:17]
    v_pk_mul_f32 v[26:27], v[78:79], v[16:17]
    v_pk_mul_f32 v[28:29], v[112:113], v[16:17]
    v_pk_mul_f32 v[30:31], v[114:115], v[16:17]
    v_pk_add_f32 v[76:77], v[76:77], v[18:19]
    v_pk_add_f32 v[78:79], v[78:79], v[18:19]
    v_exp_f32_e64 v24, v24 clamp
    v_exp_f32_e64 v25, v25 clamp
    v_exp_f32_e64 v26, v26 clamp
    v_exp_f32_e64 v27, v27 clamp
    v_pk_add_f32 v[112:113], v[112:113], v[18:19]
    v_pk_add_f32 v[114:115], v[114:115], v[18:19]
    v_exp_f32_e64 v28, v28 clamp
    v_exp_f32_e64 v29, v29 clamp
    v_exp_f32_e64 v30, v30 clamp
    v_exp_f32_e64 v31, v31 clamp
    v_pk_add_f32 v[24:25], v[24:25], v[20:21]
    v_pk_add_f32 v[26:27], v[26:27], v[20:21]
    v_max_f32 v76, v76, v24
    v_max_f32 v77, v77, v25
    v_pk_add_f32 v[28:29], v[28:29], v[20:21]
    v_pk_add_f32 v[30:31], v[30:31], v[20:21]
    v_max_f32 v78, v78, v26
    v_max_f32 v79, v79, v27
    v_max_f32 v112, v112, v28
    v_max_f32 v113, v113, v29
    v_max_f32 v114, v114, v30
    v_max_f32 v115, v115, v31
    v_cvt_pk_bf16_f32 v44, v76, v77
    v_cvt_pk_bf16_f32 v45, v78, v79
    ds_write_b64 v4, v[44:45] offset:13056
    v_cvt_pk_bf16_f32 v46, v112, v113
    v_cvt_pk_bf16_f32 v47, v114, v115
    ds_write_b64 v4, v[46:47] offset:13088
    v_mov_b32 v48, v80
    v_mov_b32 v52, v116
    v_mov_b32 v49, v81
    v_mov_b32 v53, v117
    v_mov_b32 v50, v82
    v_mov_b32 v54, v118
    v_mov_b32 v51, v83
    v_mov_b32 v55, v119
    v_pk_mul_f32 v[24:25], v[80:81], v[16:17]
    v_pk_mul_f32 v[26:27], v[82:83], v[16:17]
    v_pk_mul_f32 v[28:29], v[116:117], v[16:17]
    v_pk_mul_f32 v[30:31], v[118:119], v[16:17]
    v_pk_add_f32 v[80:81], v[80:81], v[18:19]
    v_pk_add_f32 v[82:83], v[82:83], v[18:19]
    v_exp_f32_e64 v24, v24 clamp
    v_exp_f32_e64 v25, v25 clamp
    v_exp_f32_e64 v26, v26 clamp
    v_exp_f32_e64 v27, v27 clamp
    v_pk_add_f32 v[116:117], v[116:117], v[18:19]
    v_pk_add_f32 v[118:119], v[118:119], v[18:19]
    v_exp_f32_e64 v28, v28 clamp
    v_exp_f32_e64 v29, v29 clamp
    v_exp_f32_e64 v30, v30 clamp
    v_exp_f32_e64 v31, v31 clamp
    v_pk_add_f32 v[24:25], v[24:25], v[20:21]
    v_pk_add_f32 v[26:27], v[26:27], v[20:21]
    v_max_f32 v80, v80, v24
    v_max_f32 v81, v81, v25
    v_pk_add_f32 v[28:29], v[28:29], v[20:21]
    v_pk_add_f32 v[30:31], v[30:31], v[20:21]
    v_max_f32 v82, v82, v26
    v_max_f32 v83, v83, v27
    v_max_f32 v116, v116, v28
    v_max_f32 v117, v117, v29
    v_max_f32 v118, v118, v30
    v_max_f32 v119, v119, v31
    v_cndmask_b32 v80, v48, v80, s[26:27]
    v_cndmask_b32 v116, v52, v116, s[26:27]
    v_cndmask_b32 v81, v49, v81, s[26:27]
    v_cndmask_b32 v117, v53, v117, s[26:27]
    v_cndmask_b32 v82, v50, v82, s[26:27]
    v_cndmask_b32 v118, v54, v118, s[26:27]
    v_cndmask_b32 v83, v51, v83, s[26:27]
    v_cndmask_b32 v119, v55, v119, s[26:27]
    v_cvt_pk_bf16_f32 v32, v80, v81
    v_cvt_pk_bf16_f32 v33, v82, v83
    ds_write_b64 v4, v[32:33] offset:17408
    v_cvt_pk_bf16_f32 v34, v116, v117
    v_cvt_pk_bf16_f32 v35, v118, v119
    ds_write_b64 v4, v[34:35] offset:17440
    s_mul_i32 s24, s3, 18
    v_add_u32 v8, s24, v2
    v_mul_u32_u24 v8, 272, v8
    v_lshl_add_u32 v8, v3, 4, v8
    v_add_u32 v8, 116736, v8
    v_add_u32 v5, 19584, v8
    v_add_u32 v6, 4352, v5
    v_lshlrev_b32 v7, 4, v3
    v_add_u32 v7, 160256, v7
    v_cmp_eq_u32 vcc, 2, v2
    s_nop 1
    v_cndmask_b32 v6, v6, v7, vcc
    s_waitcnt lgkmcnt(0)
    s_barrier
    v_mov_b32 v4, v8
    ds_read_b128 v[64:67], v4 offset:0
    ds_read_b128 v[72:75], v5 offset:0
    ds_read_b128 v[68:71], v4 offset:4352
    ds_read_b128 v[76:79], v6 offset:0
    ds_read_b128 v[80:83], v4 offset:64
    ds_read_b128 v[88:91], v5 offset:64
    ds_read_b128 v[84:87], v4 offset:4416
    ds_read_b128 v[92:95], v6 offset:64
    ds_read_b128 v[96:99], v4 offset:128
    ds_read_b128 v[104:107], v5 offset:128
    ds_read_b128 v[100:103], v4 offset:4480
    ds_read_b128 v[108:111], v6 offset:128
    s_waitcnt lgkmcnt(8)
    v_mfma_f32_16x16x32_bf16 v[32:35], v[64:67], v[72:75], 0
    v_mfma_f32_16x16x32_bf16 v[36:39], v[64:67], v[76:79], 0
    v_mfma_f32_16x16x32_bf16 v[40:43], v[68:71], v[72:75], 0
    v_mfma_f32_16x16x32_bf16 v[44:47], v[68:71], v[76:79], 0
    ds_read_b128 v[112:115], v4 offset:192
    ds_read_b128 v[120:123], v5 offset:192
    ds_read_b128 v[116:119], v4 offset:4544
    ds_read_b128 v[124:127], v6 offset:192
    s_waitcnt lgkmcnt(8)
    v_mfma_f32_16x16x32_bf16 v[32:35], v[80:83], v[88:91], v[32:35]
    v_mfma_f32_16x16x32_bf16 v[36:39], v[80:83], v[92:95], v[36:39]
    v_mfma_f32_16x16x32_bf16 v[40:43], v[84:87], v[88:91], v[40:43]
    v_mfma_f32_16x16x32_bf16 v[44:47], v[84:87], v[92:95], v[44:47]
    s_waitcnt lgkmcnt(4)
    v_mfma_f32_16x16x32_bf16 v[32:35], v[96:99], v[104:107], v[32:35]
    v_mfma_f32_16x16x32_bf16 v[36:39], v[96:99], v[108:111], v[36:39]
    v_mfma_f32_16x16x32_bf16 v[40:43], v[100:103], v[104:107], v[40:43]
    v_mfma_f32_16x16x32_bf16 v[44:47], v[100:103], v[108:111], v[44:47]
    s_waitcnt lgkmcnt(0)
    v_mfma_f32_16x16x32_bf16 v[32:35], v[112:115], v[120:123], v[32:35]
    v_mfma_f32_16x16x32_bf16 v[36:39], v[112:115], v[124:127], v[36:39]
    v_mfma_f32_16x16x32_bf16 v[40:43], v[116:119], v[120:123], v[40:43]
    v_mfma_f32_16x16x32_bf16 v[44:47], v[116:119], v[124:127], v[44:47]
    s_mul_i32 s27, s3, 4896
    s_add_u32 s27, s27, 116736
    v_mul_u32_u24 v4, 384, v3
    v_lshl_add_u32 v5, v2, 2, v4
    v_add_u32 v5, s27, v5
    v_cmp_eq_u32 vcc, 2, v2
    v_add_u32 v6, 64, v5
    v_add_u32 v7, 8, v6
    v_cndmask_b32 v6, v6, v7, vcc
    s_nop 4
    ds_write_b32 v5, v32 offset:0
    ds_write_b32 v5, v33 offset:96
    ds_write_b32 v5, v34 offset:192
    ds_write_b32 v5, v35 offset:288
    s_mov_b32 exec_lo, 0x00070007
    s_mov_b32 exec_hi, 0x00070007
    ds_write_b32 v6, v36 offset:0
    ds_write_b32 v6, v37 offset:96
    ds_write_b32 v6, v38 offset:192
    ds_write_b32 v6, v39 offset:288
    s_mov_b64 exec, 0xffff
    ds_write_b32 v5, v40 offset:1536
    ds_write_b32 v5, v41 offset:1632
    s_mov_b64 exec, 7
    ds_write_b32 v6, v44 offset:1536
    ds_write_b32 v6, v45 offset:1632
    s_mov_b64 exec, -1
    v_lshlrev_b32 v4, 2, v1
    v_add_u32 v5, s27, v4
    s_waitcnt lgkmcnt(0)
    ds_read_b32 v64, v5 offset:0
    ds_read_b32 v65, v5 offset:256
    ds_read_b32 v66, v5 offset:512
    ds_read_b32 v67, v5 offset:768
    ds_read_b32 v68, v5 offset:1024
    ds_read_b32 v69, v5 offset:1280
    ds_read_b32 v70, v5 offset:1536
    s_mov_b32 s12, s62
    s_and_b32 s13, s63, 0xffff
    s_mov_b32 s14, 8388608
    s_mov_b32 s15, 0x20000
    s_lshl_b32 s24, s23, 2
    s_add_u32 s24, s24, s3
    s_mul_i32 s24, s24, 1728
    s_add_u32 s24, s24, 7077888
    s_mov_b32 s38, 0
L_kv_flag:
    s_waitcnt vmcnt(0)
    v_readfirstlane_b32 s25, v60
    s_cmp_lg_u32 s25, 0
    s_cbranch_scc1 L_kv_go
    s_add_u32 s38, s38, 1
    s_cmp_ge_u32 s38, 100000
    s_cbranch_scc1 L_kv_go
    s_sleep 1
    v_mov_b32 v7, 0
    global_load_dword v60, v7, s[60:61] sc0 sc1
    s_branch L_kv_flag
L_kv_go:
    s_waitcnt lgkmcnt(0)
    s_mov_b32 exec_lo, 0xff13ffff
    s_mov_b32 exec_hi, 0xffff13ff
    buffer_atomic_add_f32 v64, v4, s[12:15], s24 offen offset:0
    s_mov_b32 exec_lo, 0x13ffff13
    s_mov_b32 exec_hi, 0xff13ffff
    buffer_atomic_add_f32 v65, v4, s[12:15], s24 offen offset:256
    s_mov_b32 exec_lo, 0xffff13ff
    s_mov_b32 exec_hi, 0x13ffff13
    buffer_atomic_add_f32 v66, v4, s[12:15], s24 offen offset:512
    s_mov_b32 exec_lo, 0xff13ffff
    s_mov_b32 exec_hi, 0xffff13ff
    buffer_atomic_add_f32 v67, v4, s[12:15], s24 offen offset:768
    s_mov_b32 exec_lo, 0x13ffff13
    s_mov_b32 exec_hi, 0xff13ffff
    buffer_atomic_add_f32 v68, v4, s[12:15], s24 offen offset:1024
    s_mov_b32 exec_lo, 0xffff13ff
    s_mov_b32 exec_hi, 0x13ffff13
    buffer_atomic_add_f32 v69, v4, s[12:15], s24 offen offset:1280
    s_mov_b32 exec_lo, 0xff13ffff
    s_mov_b32 exec_hi, 0x13ff
    buffer_atomic_add_f32 v70, v4, s[12:15], s24 offen offset:1536
    s_mov_b64 exec, -1
    s_sub_u32 s20, s2, 32
    s_cmp_ge_u32 s2, 128
    s_cselect_b32 s20, s20, s2
    s_cmp_ge_u32 s20, 96
    s_cselect_b32 s21, 1, 0
    s_cmp_ge_u32 s2, 128
    s_cselect_b32 s21, 0, s21
    s_cmp_eq_u32 s21, 1
    s_cselect_b32 s65, 1, 0
    s_waitcnt vmcnt(0)
    s_barrier
    s_cmp_eq_u32 s3, 0
    s_cbranch_scc0 L_kv_noflag
    s_add_u32 s21, s2, 128
    s_lshl_b32 s66, s21, 6
    s_add_u32 s66, s66, 7143424
    v_mov_b32 v244, s66
    v_mov_b32 v245, 1
    s_mov_b64 exec, 1
    global_store_dword v244, v245, s[62:63] sc0 sc1
    s_mov_b64 exec, -1
L_kv_noflag:
    s_cmp_eq_u32 s65, 1
    s_cbranch_scc1 L_concat_heads__linear_attn_block__ssm_conv_h3__prompt_kernel_exit
    s_branch L_A_post
L_roleQ:
    s_and_b32 s20, s2, 7
    s_sub_u32 s21, s2, 128
    s_lshr_b32 s21, s21, 3
    s_and_b32 s23, s21, 1
    s_lshl_b32 s23, s23, 3
    s_add_u32 s22, s20, s23
    s_lshr_b32 s23, s21, 1
    s_cmp_ge_u32 s3, 4
    s_cbranch_scc0 L_g1q_compute
    s_sub_u32 s25, s3, 4
    s_mov_b32 s12, s40
    s_and_b32 s13, s41, 0xffff
    s_mov_b32 s14, 2359296
    s_mov_b32 s15, 0x20000
    s_mov_b32 s16, s42
    s_and_b32 s17, s43, 0xffff
    s_mov_b32 s18, 1990656
    s_mov_b32 s19, 0x20000
    v_lshrrev_b32 v2, 3, v1
    v_and_b32 v3, 7, v1
    v_xor_b32 v3, v3, v2
    v_lshlrev_b32 v3, 4, v3
    v_mul_u32_u24 v2, 1152, v2
    v_add_u32 v2, v2, v3
    s_lshl_b32 s26, s22, 7
    s_lshl_b32 s27, s25, 3
    s_add_u32 s26, s26, s27
    s_mul_i32 s26, s26, 1152
    s_lshl_b32 s29, s25, 10
    s_add_u32 m0, s29, 0
    s_add_u32 s31, s26, 0
    buffer_load_dwordx4 v2, s[12:15], s31 offen lds
    s_add_u32 m0, s29, 4096
    s_add_u32 s31, s26, 36864
    buffer_load_dwordx4 v2, s[12:15], s31 offen lds
    s_add_u32 m0, s29, 8192
    s_add_u32 s31, s26, 73728
    buffer_load_dwordx4 v2, s[12:15], s31 offen lds
    s_add_u32 m0, s29, 12288
    s_add_u32 s31, s26, 110592
    buffer_load_dwordx4 v2, s[12:15], s31 offen lds
    s_mov_b32 s28, 0
    s_lshl_b32 s30, s25, 6
    s_mul_i32 s34, s23, 384
    v_add_u32 v12, s30, v1
    v_mul_u32_u24 v13, 2731, v12
    v_lshrrev_b32 v13, 16, v13
    v_mul_u32_u24 v14, 24, v13
    v_sub_u32 v12, v12, v14
    v_bfe_u32 v14, v13, 1, 1
    v_bfe_u32 v11, v13, 3, 1
    v_lshl_or_b32 v14, v11, 1, v14
    v_lshlrev_b32 v14, 1, v14
    v_xor_b32 v12, v12, v14
    v_mul_u32_u24 v13, 3456, v13
    v_lshl_add_u32 v13, v12, 4, v13
    v_add_u32 v4, s34, v13
    s_add_u32 m0, s29, 16384
    s_nop 0
    buffer_load_dwordx4 v4, s[16:19], s28 offen lds
    v_add_u32 v12, s30, v1
    v_add_u32 v12, 256, v12
    v_mul_u32_u24 v13, 2731, v12
    v_lshrrev_b32 v13, 16, v13
    v_mul_u32_u24 v14, 24, v13
    v_sub_u32 v12, v12, v14
    v_bfe_u32 v14, v13, 1, 1
    v_bfe_u32 v11, v13, 3, 1
    v_lshl_or_b32 v14, v11, 1, v14
    v_lshlrev_b32 v14, 1, v14
    v_xor_b32 v12, v12, v14
    v_mul_u32_u24 v13, 3456, v13
    v_lshl_add_u32 v13, v12, 4, v13
    v_add_u32 v5, s34, v13
    s_add_u32 m0, s29, 20480
    s_nop 0
    buffer_load_dwordx4 v5, s[16:19], s28 offen lds
    v_add_u32 v12, s30, v1
    v_add_u32 v12, 512, v12
    v_mul_u32_u24 v13, 2731, v12
    v_lshrrev_b32 v13, 16, v13
    v_mul_u32_u24 v14, 24, v13
    v_sub_u32 v12, v12, v14
    v_bfe_u32 v14, v13, 1, 1
    v_bfe_u32 v11, v13, 3, 1
    v_lshl_or_b32 v14, v11, 1, v14
    v_lshlrev_b32 v14, 1, v14
    v_xor_b32 v12, v12, v14
    v_mul_u32_u24 v13, 3456, v13
    v_lshl_add_u32 v13, v12, 4, v13
    v_add_u32 v6, s34, v13
    s_add_u32 m0, s29, 24576
    s_nop 0
    buffer_load_dwordx4 v6, s[16:19], s28 offen lds
    v_add_u32 v12, s30, v1
    v_add_u32 v12, 768, v12
    v_mul_u32_u24 v13, 2731, v12
    v_lshrrev_b32 v13, 16, v13
    v_mul_u32_u24 v14, 24, v13
    v_sub_u32 v12, v12, v14
    v_bfe_u32 v14, v13, 1, 1
    v_bfe_u32 v11, v13, 3, 1
    v_lshl_or_b32 v14, v11, 1, v14
    v_lshlrev_b32 v14, 1, v14
    v_xor_b32 v12, v12, v14
    v_mul_u32_u24 v13, 3456, v13
    v_lshl_add_u32 v13, v12, 4, v13
    v_add_u32 v7, s34, v13
    s_add_u32 m0, s29, 28672
    s_nop 0
    buffer_load_dwordx4 v7, s[16:19], s28 offen lds
    v_add_u32 v12, s30, v1
    v_add_u32 v12, 1024, v12
    v_mul_u32_u24 v13, 2731, v12
    v_lshrrev_b32 v13, 16, v13
    v_mul_u32_u24 v14, 24, v13
    v_sub_u32 v12, v12, v14
    v_bfe_u32 v14, v13, 1, 1
    v_bfe_u32 v11, v13, 3, 1
    v_lshl_or_b32 v14, v11, 1, v14
    v_lshlrev_b32 v14, 1, v14
    v_xor_b32 v12, v12, v14
    v_mul_u32_u24 v13, 3456, v13
    v_lshl_add_u32 v13, v12, 4, v13
    v_add_u32 v8, s34, v13
    s_add_u32 m0, s29, 32768
    s_nop 0
    buffer_load_dwordx4 v8, s[16:19], s28 offen lds
    v_add_u32 v12, s30, v1
    v_add_u32 v12, 1280, v12
    v_mul_u32_u24 v13, 2731, v12
    v_lshrrev_b32 v13, 16, v13
    v_mul_u32_u24 v14, 24, v13
    v_sub_u32 v12, v12, v14
    v_bfe_u32 v14, v13, 1, 1
    v_bfe_u32 v11, v13, 3, 1
    v_lshl_or_b32 v14, v11, 1, v14
    v_lshlrev_b32 v14, 1, v14
    v_xor_b32 v12, v12, v14
    v_mul_u32_u24 v13, 3456, v13
    v_lshl_add_u32 v13, v12, 4, v13
    v_add_u32 v9, s34, v13
    s_add_u32 m0, s29, 36864
    s_nop 0
    buffer_load_dwordx4 v9, s[16:19], s28 offen lds
    s_add_u32 s26, s26, 128
    s_add_u32 s28, s28, 221184
    s_add_u32 s29, s29, 40960
    s_cmp_ge_u32 s29, 163840
    s_cselect_b32 s37, 163840, 0
    s_sub_u32 s29, s29, s37
    s_add_u32 m0, s29, 0
    s_add_u32 s31, s26, 0
    buffer_load_dwordx4 v2, s[12:15], s31 offen lds
    s_add_u32 m0, s29, 4096
    s_add_u32 s31, s26, 36864
    buffer_load_dwordx4 v2, s[12:15], s31 offen lds
    s_add_u32 m0, s29, 8192
    s_add_u32 s31, s26, 73728
    buffer_load_dwordx4 v2, s[12:15], s31 offen lds
    s_add_u32 m0, s29, 12288
    s_add_u32 s31, s26, 110592
    buffer_load_dwordx4 v2, s[12:15], s31 offen lds
    s_add_u32 m0, s29, 16384
    s_nop 0
    buffer_load_dwordx4 v4, s[16:19], s28 offen lds
    s_add_u32 m0, s29, 20480
    s_nop 0
    buffer_load_dwordx4 v5, s[16:19], s28 offen lds
    s_add_u32 m0, s29, 24576
    s_nop 0
    buffer_load_dwordx4 v6, s[16:19], s28 offen lds
    s_add_u32 m0, s29, 28672
    s_nop 0
    buffer_load_dwordx4 v7, s[16:19], s28 offen lds
    s_add_u32 m0, s29, 32768
    s_nop 0
    buffer_load_dwordx4 v8, s[16:19], s28 offen lds
    s_add_u32 m0, s29, 36864
    s_nop 0
    buffer_load_dwordx4 v9, s[16:19], s28 offen lds
    s_mov_b32 s36, 2
L_ld_q_None_loop:
    s_waitcnt vmcnt(10)
    s_barrier
    s_add_u32 s26, s26, 128
    s_add_u32 s28, s28, 221184
    s_add_u32 s29, s29, 40960
    s_cmp_ge_u32 s29, 163840
    s_cselect_b32 s37, 163840, 0
    s_sub_u32 s29, s29, s37
    s_add_u32 m0, s29, 0
    s_add_u32 s31, s26, 0
    buffer_load_dwordx4 v2, s[12:15], s31 offen lds
    s_add_u32 m0, s29, 4096
    s_add_u32 s31, s26, 36864
    buffer_load_dwordx4 v2, s[12:15], s31 offen lds
    s_add_u32 m0, s29, 8192
    s_add_u32 s31, s26, 73728
    buffer_load_dwordx4 v2, s[12:15], s31 offen lds
    s_add_u32 m0, s29, 12288
    s_add_u32 s31, s26, 110592
    buffer_load_dwordx4 v2, s[12:15], s31 offen lds
    s_add_u32 m0, s29, 16384
    s_nop 0
    buffer_load_dwordx4 v4, s[16:19], s28 offen lds
    s_add_u32 m0, s29, 20480
    s_nop 0
    buffer_load_dwordx4 v5, s[16:19], s28 offen lds
    s_add_u32 m0, s29, 24576
    s_nop 0
    buffer_load_dwordx4 v6, s[16:19], s28 offen lds
    s_add_u32 m0, s29, 28672
    s_nop 0
    buffer_load_dwordx4 v7, s[16:19], s28 offen lds
    s_add_u32 m0, s29, 32768
    s_nop 0
    buffer_load_dwordx4 v8, s[16:19], s28 offen lds
    s_add_u32 m0, s29, 36864
    s_nop 0
    buffer_load_dwordx4 v9, s[16:19], s28 offen lds
    s_add_u32 s36, s36, 1
    s_cmp_lt_u32 s36, 9
    s_cbranch_scc1 L_ld_q_None_loop
    s_waitcnt vmcnt(10)
    s_barrier
    s_waitcnt vmcnt(0)
    s_barrier
    s_branch L_ld_q_done
L_ld_q_done:
    s_barrier
    s_sub_u32 s20, s2, 32
    s_cmp_ge_u32 s2, 128
    s_cselect_b32 s20, s20, s2
    s_cmp_ge_u32 s20, 96
    s_cselect_b32 s21, 1, 0
    s_cmp_ge_u32 s2, 128
    s_cselect_b32 s21, 0, s21
    s_cmp_eq_u32 s21, 1
    s_cbranch_scc1 L_q_idle
    s_and_b32 s22, s20, 15
    s_lshr_b32 s23, s20, 4
    s_mov_b32 s16, s44
    s_and_b32 s17, s45, 0xffff
    s_mov_b32 s18, 663552
    s_mov_b32 s19, 0x20000
    v_lshrrev_b32 v2, 3, v1
    v_and_b32 v3, 7, v1
    v_and_b32 v4, 3, v2
    v_xor_b32 v3, v3, v4
    v_lshlrev_b32 v3, 4, v3
    v_mul_u32_u24 v2, 1152, v2
    v_add_u32 v2, v2, v3
    s_lshl_b32 s82, s23, 7
    s_sub_u32 s83, s3, 4
L_g2wo_2:
    s_mul_i32 s26, s83, 3641
    s_lshr_b32 s26, s26, 16
    s_add_u32 s26, s26, s83
    s_and_b32 s26, s26, 1
    s_lshl_b32 s26, s26, 6
    v_xor_b32 v3, s26, v2
    s_lshl_b32 m0, s83, 10
    s_mul_i32 s25, s83, 9216
    s_add_u32 s25, s25, s82
    buffer_load_dwordx4 v3, s[16:19], s25 offen lds
    s_add_u32 s83, s83, 4
    s_cmp_lt_u32 s83, 40
    s_cbranch_scc1 L_g2wo_2
L_g2wo_3:
    s_mul_i32 s26, s83, 3641
    s_lshr_b32 s26, s26, 16
    s_add_u32 s26, s26, s83
    s_and_b32 s26, s26, 1
    s_lshl_b32 s26, s26, 6
    v_xor_b32 v3, s26, v2
    s_lshl_b32 m0, s83, 10
    s_mul_i32 s25, s83, 9216
    s_add_u32 s25, s25, s82
    buffer_load_dwordx4 v3, s[16:19], s25 offen lds
    s_add_u32 s83, s83, 4
    s_cmp_lt_u32 s83, 72
    s_cbranch_scc1 L_g2wo_3
    v_mov_b32 v4, 0
    v_mov_b32 v5, 0
    v_mov_b32 v6, 0
    v_mov_b32 v7, 0
    v_subrev_u32 v12, 256, v0
    v_lshlrev_b32 v13, 4, v12
    v_cmp_gt_u32 vcc, 112, v12
    s_and_saveexec_b64 s[26:27], vcc
    v_add_u32 v11, 73728, v13
    ds_write_b128 v11, v[4:7]
    s_mov_b64 exec, -1
    v_add_u32 v11, 77824, v13
    ds_write_b128 v11, v[4:7] offset:0
    ds_write_b128 v11, v[4:7] offset:4096
    ds_write_b128 v11, v[4:7] offset:8192
    ds_write_b128 v11, v[4:7] offset:12288
    ds_write_b128 v11, v[4:7] offset:16384
    ds_write_b128 v11, v[4:7] offset:20480
    ds_write_b128 v11, v[4:7] offset:24576
    ds_write_b128 v11, v[4:7] offset:28672
    ds_write_b128 v11, v[4:7] offset:32768
    s_movk_i32 s38, 60
    v_cmp_gt_u32 vcc, s38, v12
    s_and_saveexec_b64 s[26:27], vcc
    ds_write_b128 v11, v[4:7] offset:36864
    s_mov_b64 exec, -1
    v_lshlrev_b32 v215, 4, v0
    v_and_b32 v213, 15, v1
    v_lshrrev_b32 v214, 4, v1
    v_lshrrev_b32 v12, 2, v213
    v_and_b32 v13, 3, v213
    v_lshl_add_u32 v13, v12, 3, v13
    v_mul_u32_u24 v13, 288, v13
    v_add_u32 v13, 106144, v13
    v_add_u32 v14, 1152, v13
    v_mov_b32 v15, 115360
    v_cmp_eq_u32 vcc, v12, v214
    s_nop 1
    v_cndmask_b32 v233, v15, v13, vcc
    v_cndmask_b32 v234, v15, v14, vcc
    s_mul_i32 s24, s3, 18
    v_bfe_u32 v12, v1, 2, 2
    v_and_b32 v21, 3, v1
    v_lshl_add_u32 v20, v214, 3, v12
    v_add_u32 v20, s24, v20
    v_lshrrev_b32 v24, 3, v20
    v_and_b32 v24, 1, v24
    v_and_b32 v25, 3, v20
    v_lshl_or_b32 v24, v24, 2, v25
    v_lshrrev_b32 v25, 1, v21
    v_xor_b32 v24, v24, v25
    v_lshlrev_b32 v23, 7, v20
    v_lshl_add_u32 v23, v24, 4, v23
    v_and_b32 v25, 1, v21
    v_lshl_add_u32 v23, v25, 3, v23
    v_xor_b32 v200, 0, v23
    v_xor_b32 v201, 32, v23
    v_xor_b32 v202, 64, v23
    v_xor_b32 v203, 96, v23
    v_add_u32 v20, 4, v20
    v_lshrrev_b32 v24, 3, v20
    v_and_b32 v24, 1, v24
    v_and_b32 v25, 3, v20
    v_lshl_or_b32 v24, v24, 2, v25
    v_lshrrev_b32 v25, 1, v21
    v_xor_b32 v24, v24, v25
    v_lshlrev_b32 v23, 7, v20
    v_lshl_add_u32 v23, v24, 4, v23
    v_and_b32 v25, 1, v21
    v_lshl_add_u32 v23, v25, 3, v23
    v_xor_b32 v204, 0, v23
    v_xor_b32 v205, 32, v23
    v_xor_b32 v206, 64, v23
    v_xor_b32 v207, 96, v23
    v_add_u32 v20, s24, v213
    v_mul_u32_u24 v23, 304, v213
    s_mul_i32 s25, s3, 36
    v_add_u32 v23, s25, v23
    v_lshl_add_u32 v208, v214, 3, v23
    v_add_u32 v209, 4864, v208
    v_add_u32 v210, 9728, v208
    v_add_u32 v211, 14592, v208
    v_mul_u32_u24 v24, 19456, v214
    v_add_u32 v24, v24, v23
    v_add_u32 v212, 32, v24
    v_lshrrev_b32 v24, 2, v213
    v_and_b32 v25, 3, v213
    s_add_u32 s25, s24, 16
    v_mul_u32_u24 v22, 48, v20
    v_lshl_add_u32 v22, v214, 4, v22
    v_add_u32 v22, 77824, v22
    v_mov_b32 v15, 115360
    v_cmp_eq_u32 s[34:35], 3, v214
    v_cmp_gt_u32 s[38:39], 2, v25
    v_add_u32 v23, s25, v25
    v_mul_u32_u24 v23, 48, v23
    v_lshl_add_u32 v23, v214, 4, v23
    v_add_u32 v23, 77824, v23
    s_andn2_b64 s[38:39], s[38:39], s[34:35]
    v_add_u32 v28, 0, v22
    v_cndmask_b32 v216, v28, v15, s[34:35]
    v_cmp_eq_u32 vcc, 0, v24
    v_add_u32 v28, 0, v23
    s_nop 0
    s_and_b64 s[36:37], vcc, s[38:39]
    v_cndmask_b32 v220, v15, v28, s[36:37]
    v_add_u32 v28, 6912, v22
    v_cndmask_b32 v217, v28, v15, s[34:35]
    v_cmp_eq_u32 vcc, 1, v24
    v_add_u32 v28, 6912, v23
    s_nop 0
    s_and_b64 s[36:37], vcc, s[38:39]
    v_cndmask_b32 v221, v15, v28, s[36:37]
    v_add_u32 v28, 13824, v22
    v_cndmask_b32 v218, v28, v15, s[34:35]
    v_cmp_eq_u32 vcc, 2, v24
    v_add_u32 v28, 13824, v23
    s_nop 0
    s_and_b64 s[36:37], vcc, s[38:39]
    v_cndmask_b32 v222, v15, v28, s[36:37]
    v_add_u32 v28, 20736, v22
    v_cndmask_b32 v219, v28, v15, s[34:35]
    v_cmp_eq_u32 vcc, 3, v24
    v_add_u32 v28, 20736, v23
    s_nop 0
    s_and_b64 s[36:37], vcc, s[38:39]
    v_cndmask_b32 v223, v15, v28, s[36:37]
    v_add_u32 v12, 0, v0
    v_mul_u32_u24 v13, 10923, v12
    v_lshrrev_b32 v13, 16, v13
    v_mul_u32_u24 v14, 6, v13
    v_sub_u32 v14, v12, v14
    v_cmp_eq_u32 s[68:69], 5, v14
    v_mul_u32_u24 v14, 3641, v13
    v_lshrrev_b32 v15, 16, v14
    v_lshrrev_b32 v14, 19, v14
    v_mul_u32_u24 v14, 144, v14
    v_sub_u32 v14, v13, v14
    v_mul_u32_u24 v15, 288, v15
    v_lshl_add_u32 v14, v14, 1, v15
    v_add_u32 v14, 106144, v14
    v_lshlrev_b32 v12, 3, v12
    v_add_u32 v12, 77824, v12
    v_cndmask_b32 v224, v12, v14, s[68:69]
    v_add_u32 v12, 512, v0
    v_mul_u32_u24 v13, 10923, v12
    v_lshrrev_b32 v13, 16, v13
    v_mul_u32_u24 v14, 6, v13
    v_sub_u32 v14, v12, v14
    v_cmp_eq_u32 s[70:71], 5, v14
    v_mul_u32_u24 v14, 3641, v13
    v_lshrrev_b32 v15, 16, v14
    v_lshrrev_b32 v14, 19, v14
    v_mul_u32_u24 v14, 144, v14
    v_sub_u32 v14, v13, v14
    v_mul_u32_u24 v15, 288, v15
    v_lshl_add_u32 v14, v14, 1, v15
    v_add_u32 v14, 106144, v14
    v_lshlrev_b32 v12, 3, v12
    v_add_u32 v12, 77824, v12
    v_cndmask_b32 v225, v12, v14, s[70:71]
    v_add_u32 v12, 1024, v0
    v_mul_u32_u24 v13, 10923, v12
    v_lshrrev_b32 v13, 16, v13
    v_mul_u32_u24 v14, 6, v13
    v_sub_u32 v14, v12, v14
    v_cmp_eq_u32 s[72:73], 5, v14
    v_mul_u32_u24 v14, 3641, v13
    v_lshrrev_b32 v15, 16, v14
    v_lshrrev_b32 v14, 19, v14
    v_mul_u32_u24 v14, 144, v14
    v_sub_u32 v14, v13, v14
    v_mul_u32_u24 v15, 288, v15
    v_lshl_add_u32 v14, v14, 1, v15
    v_add_u32 v14, 106144, v14
    v_lshlrev_b32 v12, 3, v12
    v_add_u32 v12, 77824, v12
    v_cndmask_b32 v226, v12, v14, s[72:73]
    v_add_u32 v12, 1536, v0
    v_mul_u32_u24 v13, 10923, v12
    v_lshrrev_b32 v13, 16, v13
    v_mul_u32_u24 v14, 6, v13
    v_sub_u32 v14, v12, v14
    v_cmp_eq_u32 s[74:75], 5, v14
    v_mul_u32_u24 v14, 3641, v13
    v_lshrrev_b32 v15, 16, v14
    v_lshrrev_b32 v14, 19, v14
    v_mul_u32_u24 v14, 144, v14
    v_sub_u32 v14, v13, v14
    v_mul_u32_u24 v15, 288, v15
    v_lshl_add_u32 v14, v14, 1, v15
    v_add_u32 v14, 106144, v14
    v_lshlrev_b32 v12, 3, v12
    v_add_u32 v12, 77824, v12
    v_cndmask_b32 v227, v12, v14, s[74:75]
    v_add_u32 v12, 2048, v0
    v_mul_u32_u24 v13, 10923, v12
    v_lshrrev_b32 v13, 16, v13
    v_mul_u32_u24 v14, 6, v13
    v_sub_u32 v14, v12, v14
    v_cmp_eq_u32 s[76:77], 5, v14
    v_mul_u32_u24 v14, 3641, v13
    v_lshrrev_b32 v15, 16, v14
    v_lshrrev_b32 v14, 19, v14
    v_mul_u32_u24 v14, 144, v14
    v_sub_u32 v14, v13, v14
    v_mul_u32_u24 v15, 288, v15
    v_lshl_add_u32 v14, v14, 1, v15
    v_add_u32 v14, 106144, v14
    v_lshlrev_b32 v12, 3, v12
    v_add_u32 v12, 77824, v12
    v_cndmask_b32 v228, v12, v14, s[76:77]
    v_add_u32 v12, 2560, v0
    v_mul_u32_u24 v13, 10923, v12
    v_lshrrev_b32 v13, 16, v13
    v_mul_u32_u24 v14, 6, v13
    v_sub_u32 v14, v12, v14
    v_cmp_eq_u32 s[78:79], 5, v14
    v_mul_u32_u24 v14, 3641, v13
    v_lshrrev_b32 v15, 16, v14
    v_lshrrev_b32 v14, 19, v14
    v_mul_u32_u24 v14, 144, v14
    v_sub_u32 v14, v13, v14
    v_mul_u32_u24 v15, 288, v15
    v_lshl_add_u32 v14, v14, 1, v15
    v_add_u32 v14, 106144, v14
    v_lshlrev_b32 v12, 3, v12
    v_add_u32 v12, 77824, v12
    v_cndmask_b32 v229, v12, v14, s[78:79]
    v_add_u32 v12, 3072, v0
    v_mul_u32_u24 v13, 10923, v12
    v_lshrrev_b32 v13, 16, v13
    v_mul_u32_u24 v14, 6, v13
    v_sub_u32 v14, v12, v14
    v_cmp_eq_u32 s[80:81], 5, v14
    v_mul_u32_u24 v14, 3641, v13
    v_lshrrev_b32 v15, 16, v14
    v_lshrrev_b32 v14, 19, v14
    v_mul_u32_u24 v14, 144, v14
    v_sub_u32 v14, v13, v14
    v_mul_u32_u24 v15, 288, v15
    v_lshl_add_u32 v14, v14, 1, v15
    v_add_u32 v14, 106144, v14
    v_lshlrev_b32 v12, 3, v12
    v_add_u32 v12, 77824, v12
    v_cndmask_b32 v230, v12, v14, s[80:81]
    v_mul_u32_u24 v12, 304, v213
    v_mul_u32_u24 v13, 19456, v214
    v_add_u32 v235, v12, v13
    s_barrier
    s_waitcnt vmcnt(0)
    s_branch L_A_post
L_q_idle:
    s_barrier
    s_endpgm
L_g1q_compute:
    v_lshlrev_b32 v215, 4, v0
    v_and_b32 v213, 15, v1
    v_lshrrev_b32 v214, 4, v1
    v_lshrrev_b32 v12, 2, v213
    v_and_b32 v13, 3, v213
    v_lshl_add_u32 v13, v12, 3, v13
    v_mul_u32_u24 v13, 288, v13
    v_add_u32 v13, 106144, v13
    v_add_u32 v14, 1152, v13
    v_mov_b32 v15, 115360
    v_cmp_eq_u32 vcc, v12, v214
    s_nop 1
    v_cndmask_b32 v233, v15, v13, vcc
    v_cndmask_b32 v234, v15, v14, vcc
    s_mul_i32 s24, s3, 18
    v_bfe_u32 v12, v1, 2, 2
    v_and_b32 v21, 3, v1
    v_lshl_add_u32 v20, v214, 3, v12
    v_add_u32 v20, s24, v20
    v_lshrrev_b32 v24, 3, v20
    v_and_b32 v24, 1, v24
    v_and_b32 v25, 3, v20
    v_lshl_or_b32 v24, v24, 2, v25
    v_lshrrev_b32 v25, 1, v21
    v_xor_b32 v24, v24, v25
    v_lshlrev_b32 v23, 7, v20
    v_lshl_add_u32 v23, v24, 4, v23
    v_and_b32 v25, 1, v21
    v_lshl_add_u32 v23, v25, 3, v23
    v_xor_b32 v200, 0, v23
    v_xor_b32 v201, 32, v23
    v_xor_b32 v202, 64, v23
    v_xor_b32 v203, 96, v23
    v_add_u32 v20, 4, v20
    v_lshrrev_b32 v24, 3, v20
    v_and_b32 v24, 1, v24
    v_and_b32 v25, 3, v20
    v_lshl_or_b32 v24, v24, 2, v25
    v_lshrrev_b32 v25, 1, v21
    v_xor_b32 v24, v24, v25
    v_lshlrev_b32 v23, 7, v20
    v_lshl_add_u32 v23, v24, 4, v23
    v_and_b32 v25, 1, v21
    v_lshl_add_u32 v23, v25, 3, v23
    v_xor_b32 v204, 0, v23
    v_xor_b32 v205, 32, v23
    v_xor_b32 v206, 64, v23
    v_xor_b32 v207, 96, v23
    v_add_u32 v20, s24, v213
    v_mul_u32_u24 v23, 304, v213
    s_mul_i32 s25, s3, 36
    v_add_u32 v23, s25, v23
    v_lshl_add_u32 v208, v214, 3, v23
    v_add_u32 v209, 4864, v208
    v_add_u32 v210, 9728, v208
    v_add_u32 v211, 14592, v208
    v_mul_u32_u24 v24, 19456, v214
    v_add_u32 v24, v24, v23
    v_add_u32 v212, 32, v24
    v_lshrrev_b32 v24, 2, v213
    v_and_b32 v25, 3, v213
    s_add_u32 s25, s24, 16
    v_mul_u32_u24 v22, 48, v20
    v_lshl_add_u32 v22, v214, 4, v22
    v_add_u32 v22, 77824, v22
    v_mov_b32 v15, 115360
    v_cmp_eq_u32 s[34:35], 3, v214
    v_cmp_gt_u32 s[38:39], 2, v25
    v_add_u32 v23, s25, v25
    v_mul_u32_u24 v23, 48, v23
    v_lshl_add_u32 v23, v214, 4, v23
    v_add_u32 v23, 77824, v23
    s_andn2_b64 s[38:39], s[38:39], s[34:35]
    v_add_u32 v28, 0, v22
    v_cndmask_b32 v216, v28, v15, s[34:35]
    v_cmp_eq_u32 vcc, 0, v24
    v_add_u32 v28, 0, v23
    s_nop 0
    s_and_b64 s[36:37], vcc, s[38:39]
    v_cndmask_b32 v220, v15, v28, s[36:37]
    v_add_u32 v28, 6912, v22
    v_cndmask_b32 v217, v28, v15, s[34:35]
    v_cmp_eq_u32 vcc, 1, v24
    v_add_u32 v28, 6912, v23
    s_nop 0
    s_and_b64 s[36:37], vcc, s[38:39]
    v_cndmask_b32 v221, v15, v28, s[36:37]
    v_add_u32 v28, 13824, v22
    v_cndmask_b32 v218, v28, v15, s[34:35]
    v_cmp_eq_u32 vcc, 2, v24
    v_add_u32 v28, 13824, v23
    s_nop 0
    s_and_b64 s[36:37], vcc, s[38:39]
    v_cndmask_b32 v222, v15, v28, s[36:37]
    v_add_u32 v28, 20736, v22
    v_cndmask_b32 v219, v28, v15, s[34:35]
    v_cmp_eq_u32 vcc, 3, v24
    v_add_u32 v28, 20736, v23
    s_nop 0
    s_and_b64 s[36:37], vcc, s[38:39]
    v_cndmask_b32 v223, v15, v28, s[36:37]
    v_add_u32 v12, 0, v0
    v_mul_u32_u24 v13, 10923, v12
    v_lshrrev_b32 v13, 16, v13
    v_mul_u32_u24 v14, 6, v13
    v_sub_u32 v14, v12, v14
    v_cmp_eq_u32 s[68:69], 5, v14
    v_mul_u32_u24 v14, 3641, v13
    v_lshrrev_b32 v15, 16, v14
    v_lshrrev_b32 v14, 19, v14
    v_mul_u32_u24 v14, 144, v14
    v_sub_u32 v14, v13, v14
    v_mul_u32_u24 v15, 288, v15
    v_lshl_add_u32 v14, v14, 1, v15
    v_add_u32 v14, 106144, v14
    v_lshlrev_b32 v12, 3, v12
    v_add_u32 v12, 77824, v12
    v_cndmask_b32 v224, v12, v14, s[68:69]
    v_add_u32 v12, 512, v0
    v_mul_u32_u24 v13, 10923, v12
    v_lshrrev_b32 v13, 16, v13
    v_mul_u32_u24 v14, 6, v13
    v_sub_u32 v14, v12, v14
    v_cmp_eq_u32 s[70:71], 5, v14
    v_mul_u32_u24 v14, 3641, v13
    v_lshrrev_b32 v15, 16, v14
    v_lshrrev_b32 v14, 19, v14
    v_mul_u32_u24 v14, 144, v14
    v_sub_u32 v14, v13, v14
    v_mul_u32_u24 v15, 288, v15
    v_lshl_add_u32 v14, v14, 1, v15
    v_add_u32 v14, 106144, v14
    v_lshlrev_b32 v12, 3, v12
    v_add_u32 v12, 77824, v12
    v_cndmask_b32 v225, v12, v14, s[70:71]
    v_add_u32 v12, 1024, v0
    v_mul_u32_u24 v13, 10923, v12
    v_lshrrev_b32 v13, 16, v13
    v_mul_u32_u24 v14, 6, v13
    v_sub_u32 v14, v12, v14
    v_cmp_eq_u32 s[72:73], 5, v14
    v_mul_u32_u24 v14, 3641, v13
    v_lshrrev_b32 v15, 16, v14
    v_lshrrev_b32 v14, 19, v14
    v_mul_u32_u24 v14, 144, v14
    v_sub_u32 v14, v13, v14
    v_mul_u32_u24 v15, 288, v15
    v_lshl_add_u32 v14, v14, 1, v15
    v_add_u32 v14, 106144, v14
    v_lshlrev_b32 v12, 3, v12
    v_add_u32 v12, 77824, v12
    v_cndmask_b32 v226, v12, v14, s[72:73]
    v_add_u32 v12, 1536, v0
    v_mul_u32_u24 v13, 10923, v12
    v_lshrrev_b32 v13, 16, v13
    v_mul_u32_u24 v14, 6, v13
    v_sub_u32 v14, v12, v14
    v_cmp_eq_u32 s[74:75], 5, v14
    v_mul_u32_u24 v14, 3641, v13
    v_lshrrev_b32 v15, 16, v14
    v_lshrrev_b32 v14, 19, v14
    v_mul_u32_u24 v14, 144, v14
    v_sub_u32 v14, v13, v14
    v_mul_u32_u24 v15, 288, v15
    v_lshl_add_u32 v14, v14, 1, v15
    v_add_u32 v14, 106144, v14
    v_lshlrev_b32 v12, 3, v12
    v_add_u32 v12, 77824, v12
    v_cndmask_b32 v227, v12, v14, s[74:75]
    v_add_u32 v12, 2048, v0
    v_mul_u32_u24 v13, 10923, v12
    v_lshrrev_b32 v13, 16, v13
    v_mul_u32_u24 v14, 6, v13
    v_sub_u32 v14, v12, v14
    v_cmp_eq_u32 s[76:77], 5, v14
    v_mul_u32_u24 v14, 3641, v13
    v_lshrrev_b32 v15, 16, v14
    v_lshrrev_b32 v14, 19, v14
    v_mul_u32_u24 v14, 144, v14
    v_sub_u32 v14, v13, v14
    v_mul_u32_u24 v15, 288, v15
    v_lshl_add_u32 v14, v14, 1, v15
    v_add_u32 v14, 106144, v14
    v_lshlrev_b32 v12, 3, v12
    v_add_u32 v12, 77824, v12
    v_cndmask_b32 v228, v12, v14, s[76:77]
    v_add_u32 v12, 2560, v0
    v_mul_u32_u24 v13, 10923, v12
    v_lshrrev_b32 v13, 16, v13
    v_mul_u32_u24 v14, 6, v13
    v_sub_u32 v14, v12, v14
    v_cmp_eq_u32 s[78:79], 5, v14
    v_mul_u32_u24 v14, 3641, v13
    v_lshrrev_b32 v15, 16, v14
    v_lshrrev_b32 v14, 19, v14
    v_mul_u32_u24 v14, 144, v14
    v_sub_u32 v14, v13, v14
    v_mul_u32_u24 v15, 288, v15
    v_lshl_add_u32 v14, v14, 1, v15
    v_add_u32 v14, 106144, v14
    v_lshlrev_b32 v12, 3, v12
    v_add_u32 v12, 77824, v12
    v_cndmask_b32 v229, v12, v14, s[78:79]
    v_add_u32 v12, 3072, v0
    v_mul_u32_u24 v13, 10923, v12
    v_lshrrev_b32 v13, 16, v13
    v_mul_u32_u24 v14, 6, v13
    v_sub_u32 v14, v12, v14
    v_cmp_eq_u32 s[80:81], 5, v14
    v_mul_u32_u24 v14, 3641, v13
    v_lshrrev_b32 v15, 16, v14
    v_lshrrev_b32 v14, 19, v14
    v_mul_u32_u24 v14, 144, v14
    v_sub_u32 v14, v13, v14
    v_mul_u32_u24 v15, 288, v15
    v_lshl_add_u32 v14, v14, 1, v15
    v_add_u32 v14, 106144, v14
    v_lshlrev_b32 v12, 3, v12
    v_add_u32 v12, 77824, v12
    v_cndmask_b32 v230, v12, v14, s[80:81]
    v_mul_u32_u24 v12, 304, v213
    v_mul_u32_u24 v13, 19456, v214
    v_add_u32 v235, v12, v13
    v_and_b32 v2, 15, v1
    v_lshrrev_b32 v3, 4, v1
    s_lshr_b32 s30, s3, 1
    s_and_b32 s31, s3, 1
    s_lshl_b32 s24, s30, 13
    v_and_b32 v4, 7, v2
    v_xor_b32 v4, v4, v3
    v_lshlrev_b32 v5, 7, v2
    v_lshl_add_u32 v5, v4, 4, v5
    v_add_u32 v6, s24, v5
    v_xor_b32 v7, 64, v6
    v_bfe_u32 v4, v1, 2, 2
    v_lshl_add_u32 v5, v3, 3, v4
    v_mul_u32_u24 v5, 384, v5
    v_and_b32 v8, 3, v1
    v_lshl_add_u32 v5, v8, 3, v5
    v_add_u32 v5, 16384, v5
    v_lshrrev_b32 v4, 1, v4
    v_and_b32 v8, 1, v3
    v_lshl_or_b32 v4, v8, 1, v4
    s_mul_i32 s32, s31, 6
    s_add_u32 s33, s32, 0
    s_and_b32 s34, s33, 3
    s_lshr_b32 s33, s33, 2
    s_lshl_b32 s33, s33, 7
    v_xor_b32 v14, s34, v4
    v_lshl_add_u32 v14, v14, 5, v5
    v_add_u32 v8, s33, v14
    s_add_u32 s33, s32, 1
    s_and_b32 s34, s33, 3
    s_lshr_b32 s33, s33, 2
    s_lshl_b32 s33, s33, 7
    v_xor_b32 v14, s34, v4
    v_lshl_add_u32 v14, v14, 5, v5
    v_add_u32 v9, s33, v14
    s_add_u32 s33, s32, 2
    s_and_b32 s34, s33, 3
    s_lshr_b32 s33, s33, 2
    s_lshl_b32 s33, s33, 7
    v_xor_b32 v14, s34, v4
    v_lshl_add_u32 v14, v14, 5, v5
    v_add_u32 v10, s33, v14
    s_add_u32 s33, s32, 3
    s_and_b32 s34, s33, 3
    s_lshr_b32 s33, s33, 2
    s_lshl_b32 s33, s33, 7
    v_xor_b32 v14, s34, v4
    v_lshl_add_u32 v14, v14, 5, v5
    v_add_u32 v11, s33, v14
    s_add_u32 s33, s32, 4
    s_and_b32 s34, s33, 3
    s_lshr_b32 s33, s33, 2
    s_lshl_b32 s33, s33, 7
    v_xor_b32 v14, s34, v4
    v_lshl_add_u32 v14, v14, 5, v5
    v_add_u32 v12, s33, v14
    s_add_u32 s33, s32, 5
    s_and_b32 s34, s33, 3
    s_lshr_b32 s33, s33, 2
    s_lshl_b32 s33, s33, 7
    v_xor_b32 v14, s34, v4
    v_lshl_add_u32 v14, v14, 5, v5
    v_add_u32 v13, s33, v14
    v_mov_b32 v64, 0
    v_mov_b32 v65, 0
    v_mov_b32 v66, 0
    v_mov_b32 v67, 0
    v_mov_b32 v68, 0
    v_mov_b32 v69, 0
    v_mov_b32 v70, 0
    v_mov_b32 v71, 0
    v_mov_b32 v72, 0
    v_mov_b32 v73, 0
    v_mov_b32 v74, 0
    v_mov_b32 v75, 0
    v_mov_b32 v76, 0
    v_mov_b32 v77, 0
    v_mov_b32 v78, 0
    v_mov_b32 v79, 0
    v_mov_b32 v80, 0
    v_mov_b32 v81, 0
    v_mov_b32 v82, 0
    v_mov_b32 v83, 0
    v_mov_b32 v84, 0
    v_mov_b32 v85, 0
    v_mov_b32 v86, 0
    v_mov_b32 v87, 0
    v_mov_b32 v88, 0
    v_mov_b32 v89, 0
    v_mov_b32 v90, 0
    v_mov_b32 v91, 0
    v_mov_b32 v92, 0
    v_mov_b32 v93, 0
    v_mov_b32 v94, 0
    v_mov_b32 v95, 0
    v_mov_b32 v96, 0
    v_mov_b32 v97, 0
    v_mov_b32 v98, 0
    v_mov_b32 v99, 0
    v_mov_b32 v100, 0
    v_mov_b32 v101, 0
    v_mov_b32 v102, 0
    v_mov_b32 v103, 0
    v_mov_b32 v104, 0
    v_mov_b32 v105, 0
    v_mov_b32 v106, 0
    v_mov_b32 v107, 0
    v_mov_b32 v108, 0
    v_mov_b32 v109, 0
    v_mov_b32 v110, 0
    v_mov_b32 v111, 0
    v_mov_b32 v112, 0
    v_mov_b32 v113, 0
    v_mov_b32 v114, 0
    v_mov_b32 v115, 0
    v_mov_b32 v116, 0
    v_mov_b32 v117, 0
    v_mov_b32 v118, 0
    v_mov_b32 v119, 0
    v_mov_b32 v120, 0
    v_mov_b32 v121, 0
    v_mov_b32 v122, 0
    v_mov_b32 v123, 0
    v_mov_b32 v124, 0
    v_mov_b32 v125, 0
    v_mov_b32 v126, 0
    v_mov_b32 v127, 0
    v_mov_b32 v128, 0
    v_mov_b32 v129, 0
    v_mov_b32 v130, 0
    v_mov_b32 v131, 0
    v_mov_b32 v132, 0
    v_mov_b32 v133, 0
    v_mov_b32 v134, 0
    v_mov_b32 v135, 0
    v_mov_b32 v136, 0
    v_mov_b32 v137, 0
    v_mov_b32 v138, 0
    v_mov_b32 v139, 0
    v_mov_b32 v140, 0
    v_mov_b32 v141, 0
    v_mov_b32 v142, 0
    v_mov_b32 v143, 0
    v_mov_b32 v144, 0
    v_mov_b32 v145, 0
    v_mov_b32 v146, 0
    v_mov_b32 v147, 0
    v_mov_b32 v148, 0
    v_mov_b32 v149, 0
    v_mov_b32 v150, 0
    v_mov_b32 v151, 0
    v_mov_b32 v152, 0
    v_mov_b32 v153, 0
    v_mov_b32 v154, 0
    v_mov_b32 v155, 0
    v_mov_b32 v156, 0
    v_mov_b32 v157, 0
    v_mov_b32 v158, 0
    v_mov_b32 v159, 0
    s_mov_b32 s24, 0
    s_mov_b32 s25, 0
    v_mov_b32 v14, v6
    v_mov_b32 v15, v7
    v_mov_b32 v236, v8
    v_mov_b32 v237, v9
    v_mov_b32 v238, v10
    v_mov_b32 v239, v11
    v_mov_b32 v240, v12
    v_mov_b32 v241, v13
    s_barrier
    ds_read_b128 v[16:19], v14 offset:0
    ds_read_b64_tr_b16 v[160:161], v236 offset:0
    ds_read_b64_tr_b16 v[162:163], v236 offset:1536
    ds_read_b128 v[20:23], v14 offset:2048
    ds_read_b128 v[24:27], v14 offset:4096
    ds_read_b128 v[28:31], v14 offset:6144
    ds_read_b64_tr_b16 v[164:165], v237 offset:0
    ds_read_b64_tr_b16 v[166:167], v237 offset:1536
    ds_read_b64_tr_b16 v[168:169], v238 offset:0
    ds_read_b64_tr_b16 v[170:171], v238 offset:1536
    ds_read_b64_tr_b16 v[172:173], v239 offset:0
    ds_read_b64_tr_b16 v[174:175], v239 offset:1536
    s_waitcnt lgkmcnt(9)
    v_mfma_f32_16x16x32_bf16 v[64:67], v[160:163], v[16:19], v[64:67]
    s_waitcnt lgkmcnt(8)
    v_mfma_f32_16x16x32_bf16 v[88:91], v[160:163], v[20:23], v[88:91]
    ds_read_b64_tr_b16 v[176:177], v240 offset:0
    ds_read_b64_tr_b16 v[178:179], v240 offset:1536
    s_waitcnt lgkmcnt(9)
    v_mfma_f32_16x16x32_bf16 v[112:115], v[160:163], v[24:27], v[112:115]
    s_waitcnt lgkmcnt(8)
    v_mfma_f32_16x16x32_bf16 v[136:139], v[160:163], v[28:31], v[136:139]
    s_waitcnt lgkmcnt(6)
    v_mfma_f32_16x16x32_bf16 v[68:71], v[164:167], v[16:19], v[68:71]
    v_mfma_f32_16x16x32_bf16 v[92:95], v[164:167], v[20:23], v[92:95]
    ds_read_b64_tr_b16 v[180:181], v241 offset:0
    ds_read_b64_tr_b16 v[182:183], v241 offset:1536
    v_mfma_f32_16x16x32_bf16 v[116:119], v[164:167], v[24:27], v[116:119]
    v_mfma_f32_16x16x32_bf16 v[140:143], v[164:167], v[28:31], v[140:143]
    ds_read_b128 v[32:35], v15 offset:0
    s_waitcnt lgkmcnt(7)
    v_mfma_f32_16x16x32_bf16 v[72:75], v[168:171], v[16:19], v[72:75]
    v_mfma_f32_16x16x32_bf16 v[96:99], v[168:171], v[20:23], v[96:99]
    ds_read_b64_tr_b16 v[160:161], v236 offset:12288
    ds_read_b64_tr_b16 v[162:163], v236 offset:13824
    v_mfma_f32_16x16x32_bf16 v[120:123], v[168:171], v[24:27], v[120:123]
    v_mfma_f32_16x16x32_bf16 v[144:147], v[168:171], v[28:31], v[144:147]
    ds_read_b128 v[36:39], v15 offset:2048
    s_waitcnt lgkmcnt(8)
    v_mfma_f32_16x16x32_bf16 v[76:79], v[172:175], v[16:19], v[76:79]
    v_mfma_f32_16x16x32_bf16 v[100:103], v[172:175], v[20:23], v[100:103]
    ds_read_b64_tr_b16 v[164:165], v237 offset:12288
    ds_read_b64_tr_b16 v[166:167], v237 offset:13824
    v_mfma_f32_16x16x32_bf16 v[124:127], v[172:175], v[24:27], v[124:127]
    v_mfma_f32_16x16x32_bf16 v[148:151], v[172:175], v[28:31], v[148:151]
    ds_read_b128 v[40:43], v15 offset:4096
    s_waitcnt lgkmcnt(9)
    v_mfma_f32_16x16x32_bf16 v[80:83], v[176:179], v[16:19], v[80:83]
    v_mfma_f32_16x16x32_bf16 v[104:107], v[176:179], v[20:23], v[104:107]
    ds_read_b64_tr_b16 v[168:169], v238 offset:12288
    ds_read_b64_tr_b16 v[170:171], v238 offset:13824
    v_mfma_f32_16x16x32_bf16 v[128:131], v[176:179], v[24:27], v[128:131]
    v_mfma_f32_16x16x32_bf16 v[152:155], v[176:179], v[28:31], v[152:155]
    ds_read_b128 v[44:47], v15 offset:6144
    s_waitcnt lgkmcnt(10)
    v_mfma_f32_16x16x32_bf16 v[84:87], v[180:183], v[16:19], v[84:87]
    v_mfma_f32_16x16x32_bf16 v[108:111], v[180:183], v[20:23], v[108:111]
    ds_read_b64_tr_b16 v[172:173], v239 offset:12288
    ds_read_b64_tr_b16 v[174:175], v239 offset:13824
    v_mfma_f32_16x16x32_bf16 v[132:135], v[180:183], v[24:27], v[132:135]
    v_mfma_f32_16x16x32_bf16 v[156:159], v[180:183], v[28:31], v[156:159]
L_g1q_loop:
    s_barrier
    s_waitcnt lgkmcnt(9)
    v_mfma_f32_16x16x32_bf16 v[64:67], v[160:163], v[32:35], v[64:67]
    s_waitcnt lgkmcnt(8)
    v_mfma_f32_16x16x32_bf16 v[88:91], v[160:163], v[36:39], v[88:91]
    ds_read_b64_tr_b16 v[176:177], v240 offset:12288
    ds_read_b64_tr_b16 v[178:179], v240 offset:13824
    s_waitcnt lgkmcnt(7)
    v_mfma_f32_16x16x32_bf16 v[112:115], v[160:163], v[40:43], v[112:115]
    s_waitcnt lgkmcnt(4)
    v_mfma_f32_16x16x32_bf16 v[136:139], v[160:163], v[44:47], v[136:139]
    v_mfma_f32_16x16x32_bf16 v[68:71], v[164:167], v[32:35], v[68:71]
    v_mfma_f32_16x16x32_bf16 v[92:95], v[164:167], v[36:39], v[92:95]
    ds_read_b64_tr_b16 v[180:181], v241 offset:12288
    ds_read_b64_tr_b16 v[182:183], v241 offset:13824
    v_mfma_f32_16x16x32_bf16 v[116:119], v[164:167], v[40:43], v[116:119]
    v_mfma_f32_16x16x32_bf16 v[140:143], v[164:167], v[44:47], v[140:143]
    v_mfma_f32_16x16x32_bf16 v[72:75], v[168:171], v[32:35], v[72:75]
    v_mfma_f32_16x16x32_bf16 v[96:99], v[168:171], v[36:39], v[96:99]
    s_add_u32 s25, s25, 40960
    s_cmp_ge_u32 s25, 163840
    s_cselect_b32 s37, 163840, 0
    s_sub_u32 s25, s25, s37
    v_add_u32 v14, s25, v6
    v_add_u32 v15, s25, v7
    v_add_u32 v236, s25, v8
    v_add_u32 v237, s25, v9
    v_add_u32 v238, s25, v10
    v_add_u32 v239, s25, v11
    v_add_u32 v240, s25, v12
    v_add_u32 v241, s25, v13
    ds_read_b64_tr_b16 v[160:161], v236 offset:0
    ds_read_b64_tr_b16 v[162:163], v236 offset:1536
    v_mfma_f32_16x16x32_bf16 v[120:123], v[168:171], v[40:43], v[120:123]
    v_mfma_f32_16x16x32_bf16 v[144:147], v[168:171], v[44:47], v[144:147]
    s_waitcnt lgkmcnt(6)
    v_mfma_f32_16x16x32_bf16 v[76:79], v[172:175], v[32:35], v[76:79]
    v_mfma_f32_16x16x32_bf16 v[100:103], v[172:175], v[36:39], v[100:103]
    ds_read_b64_tr_b16 v[164:165], v237 offset:0
    ds_read_b64_tr_b16 v[166:167], v237 offset:1536
    v_mfma_f32_16x16x32_bf16 v[124:127], v[172:175], v[40:43], v[124:127]
    v_mfma_f32_16x16x32_bf16 v[148:151], v[172:175], v[44:47], v[148:151]
    ds_read_b128 v[16:19], v14 offset:0
    s_waitcnt lgkmcnt(7)
    v_mfma_f32_16x16x32_bf16 v[80:83], v[176:179], v[32:35], v[80:83]
    v_mfma_f32_16x16x32_bf16 v[104:107], v[176:179], v[36:39], v[104:107]
    ds_read_b64_tr_b16 v[168:169], v238 offset:0
    ds_read_b64_tr_b16 v[170:171], v238 offset:1536
    v_mfma_f32_16x16x32_bf16 v[128:131], v[176:179], v[40:43], v[128:131]
    v_mfma_f32_16x16x32_bf16 v[152:155], v[176:179], v[44:47], v[152:155]
    ds_read_b128 v[20:23], v14 offset:2048
    s_waitcnt lgkmcnt(8)
    v_mfma_f32_16x16x32_bf16 v[84:87], v[180:183], v[32:35], v[84:87]
    v_mfma_f32_16x16x32_bf16 v[108:111], v[180:183], v[36:39], v[108:111]
    ds_read_b64_tr_b16 v[172:173], v239 offset:0
    ds_read_b64_tr_b16 v[174:175], v239 offset:1536
    v_mfma_f32_16x16x32_bf16 v[132:135], v[180:183], v[40:43], v[132:135]
    v_mfma_f32_16x16x32_bf16 v[156:159], v[180:183], v[44:47], v[156:159]
    ds_read_b128 v[24:27], v14 offset:4096
    ds_read_b128 v[28:31], v14 offset:6144
    s_waitcnt lgkmcnt(7)
    v_mfma_f32_16x16x32_bf16 v[64:67], v[160:163], v[16:19], v[64:67]
    s_waitcnt lgkmcnt(4)
    v_mfma_f32_16x16x32_bf16 v[88:91], v[160:163], v[20:23], v[88:91]
    ds_read_b64_tr_b16 v[176:177], v240 offset:0
    ds_read_b64_tr_b16 v[178:179], v240 offset:1536
    s_waitcnt lgkmcnt(3)
    v_mfma_f32_16x16x32_bf16 v[112:115], v[160:163], v[24:27], v[112:115]
    s_waitcnt lgkmcnt(2)
    v_mfma_f32_16x16x32_bf16 v[136:139], v[160:163], v[28:31], v[136:139]
    v_mfma_f32_16x16x32_bf16 v[68:71], v[164:167], v[16:19], v[68:71]
    v_mfma_f32_16x16x32_bf16 v[92:95], v[164:167], v[20:23], v[92:95]
    ds_read_b64_tr_b16 v[180:181], v241 offset:0
    ds_read_b64_tr_b16 v[182:183], v241 offset:1536
    v_mfma_f32_16x16x32_bf16 v[116:119], v[164:167], v[24:27], v[116:119]
    v_mfma_f32_16x16x32_bf16 v[140:143], v[164:167], v[28:31], v[140:143]
    ds_read_b128 v[32:35], v15 offset:0
    v_mfma_f32_16x16x32_bf16 v[72:75], v[168:171], v[16:19], v[72:75]
    v_mfma_f32_16x16x32_bf16 v[96:99], v[168:171], v[20:23], v[96:99]
    ds_read_b64_tr_b16 v[160:161], v236 offset:12288
    ds_read_b64_tr_b16 v[162:163], v236 offset:13824
    v_mfma_f32_16x16x32_bf16 v[120:123], v[168:171], v[24:27], v[120:123]
    v_mfma_f32_16x16x32_bf16 v[144:147], v[168:171], v[28:31], v[144:147]
    ds_read_b128 v[36:39], v15 offset:2048
    v_mfma_f32_16x16x32_bf16 v[76:79], v[172:175], v[16:19], v[76:79]
    v_mfma_f32_16x16x32_bf16 v[100:103], v[172:175], v[20:23], v[100:103]
    ds_read_b64_tr_b16 v[164:165], v237 offset:12288
    ds_read_b64_tr_b16 v[166:167], v237 offset:13824
    v_mfma_f32_16x16x32_bf16 v[124:127], v[172:175], v[24:27], v[124:127]
    v_mfma_f32_16x16x32_bf16 v[148:151], v[172:175], v[28:31], v[148:151]
    ds_read_b128 v[40:43], v15 offset:4096
    s_waitcnt lgkmcnt(9)
    v_mfma_f32_16x16x32_bf16 v[80:83], v[176:179], v[16:19], v[80:83]
    v_mfma_f32_16x16x32_bf16 v[104:107], v[176:179], v[20:23], v[104:107]
    ds_read_b64_tr_b16 v[168:169], v238 offset:12288
    ds_read_b64_tr_b16 v[170:171], v238 offset:13824
    v_mfma_f32_16x16x32_bf16 v[128:131], v[176:179], v[24:27], v[128:131]
    v_mfma_f32_16x16x32_bf16 v[152:155], v[176:179], v[28:31], v[152:155]
    ds_read_b128 v[44:47], v15 offset:6144
    s_waitcnt lgkmcnt(10)
    v_mfma_f32_16x16x32_bf16 v[84:87], v[180:183], v[16:19], v[84:87]
    v_mfma_f32_16x16x32_bf16 v[108:111], v[180:183], v[20:23], v[108:111]
    ds_read_b64_tr_b16 v[172:173], v239 offset:12288
    ds_read_b64_tr_b16 v[174:175], v239 offset:13824
    v_mfma_f32_16x16x32_bf16 v[132:135], v[180:183], v[24:27], v[132:135]
    v_mfma_f32_16x16x32_bf16 v[156:159], v[180:183], v[28:31], v[156:159]
    s_add_u32 s24, s24, 1
    s_cmp_lt_u32 s24, 8
    s_cbranch_scc1 L_g1q_loop
    s_waitcnt lgkmcnt(9)
    v_mfma_f32_16x16x32_bf16 v[64:67], v[160:163], v[32:35], v[64:67]
    s_waitcnt lgkmcnt(8)
    v_mfma_f32_16x16x32_bf16 v[88:91], v[160:163], v[36:39], v[88:91]
    ds_read_b64_tr_b16 v[176:177], v240 offset:12288
    ds_read_b64_tr_b16 v[178:179], v240 offset:13824
    s_waitcnt lgkmcnt(7)
    v_mfma_f32_16x16x32_bf16 v[112:115], v[160:163], v[40:43], v[112:115]
    s_waitcnt lgkmcnt(4)
    v_mfma_f32_16x16x32_bf16 v[136:139], v[160:163], v[44:47], v[136:139]
    v_mfma_f32_16x16x32_bf16 v[68:71], v[164:167], v[32:35], v[68:71]
    v_mfma_f32_16x16x32_bf16 v[92:95], v[164:167], v[36:39], v[92:95]
    ds_read_b64_tr_b16 v[180:181], v241 offset:12288
    ds_read_b64_tr_b16 v[182:183], v241 offset:13824
    v_mfma_f32_16x16x32_bf16 v[116:119], v[164:167], v[40:43], v[116:119]
    v_mfma_f32_16x16x32_bf16 v[140:143], v[164:167], v[44:47], v[140:143]
    v_mfma_f32_16x16x32_bf16 v[72:75], v[168:171], v[32:35], v[72:75]
    v_mfma_f32_16x16x32_bf16 v[96:99], v[168:171], v[36:39], v[96:99]
    v_mfma_f32_16x16x32_bf16 v[120:123], v[168:171], v[40:43], v[120:123]
    v_mfma_f32_16x16x32_bf16 v[144:147], v[168:171], v[44:47], v[144:147]
    s_waitcnt lgkmcnt(4)
    v_mfma_f32_16x16x32_bf16 v[76:79], v[172:175], v[32:35], v[76:79]
    v_mfma_f32_16x16x32_bf16 v[100:103], v[172:175], v[36:39], v[100:103]
    v_mfma_f32_16x16x32_bf16 v[124:127], v[172:175], v[40:43], v[124:127]
    v_mfma_f32_16x16x32_bf16 v[148:151], v[172:175], v[44:47], v[148:151]
    s_waitcnt lgkmcnt(2)
    v_mfma_f32_16x16x32_bf16 v[80:83], v[176:179], v[32:35], v[80:83]
    v_mfma_f32_16x16x32_bf16 v[104:107], v[176:179], v[36:39], v[104:107]
    v_mfma_f32_16x16x32_bf16 v[128:131], v[176:179], v[40:43], v[128:131]
    v_mfma_f32_16x16x32_bf16 v[152:155], v[176:179], v[44:47], v[152:155]
    s_waitcnt lgkmcnt(0)
    v_mfma_f32_16x16x32_bf16 v[84:87], v[180:183], v[32:35], v[84:87]
    v_mfma_f32_16x16x32_bf16 v[108:111], v[180:183], v[36:39], v[108:111]
    v_mfma_f32_16x16x32_bf16 v[132:135], v[180:183], v[40:43], v[132:135]
    v_mfma_f32_16x16x32_bf16 v[156:159], v[180:183], v[44:47], v[156:159]
    s_barrier
    v_mov_b32 v15, 0
    global_load_dword v14, v15, s[60:61] sc0 sc1
    v_mov_b32 v16, 0x3fb8aa3b
    v_mov_b32 v17, 0x3fb8aa3b
    v_mov_b32 v18, 0x3f800008
    v_mov_b32 v19, 0x3f800008
    v_mov_b32 v20, 0x358637bd
    v_mov_b32 v21, 0x358637bd
    s_mov_b32 s12, s62
    s_and_b32 s13, s63, 0xffff
    s_mov_b32 s14, 8388608
    s_mov_b32 s15, 0x20000
    v_and_b32 v5, 1, v3
    v_lshlrev_b32 v4, 10, v5
    v_lshl_add_u32 v4, v2, 4, v4
    v_cmp_gt_u32 s[34:35], 2, v3
    s_lshl_b32 s25, s22, 3
    s_lshl_b32 s26, s30, 2
    s_add_u32 s25, s25, s26
    s_mul_i32 s25, s25, 18432
    s_add_u32 s25, s25, 4718592
    s_mul_i32 s27, s23, 12
    s_mul_i32 s26, s31, 6
    s_add_u32 s27, s27, s26
    s_add_u32 s28, s27, 0
    s_mul_i32 s29, s28, 7282
    s_lshr_b32 s29, s29, 16
    s_mul_i32 s36, s29, 9
    s_sub_u32 s36, s28, s36
    s_lshl_b32 s36, s36, 11
    s_lshl_b32 s29, s29, 8
    s_add_u32 s84, s29, s36
    s_add_u32 s28, s27, 1
    s_mul_i32 s29, s28, 7282
    s_lshr_b32 s29, s29, 16
    s_mul_i32 s36, s29, 9
    s_sub_u32 s36, s28, s36
    s_lshl_b32 s36, s36, 11
    s_lshl_b32 s29, s29, 8
    s_add_u32 s85, s29, s36
    v_mov_b32 v6, s85
    v_mov_b32 v7, s84
    v_cndmask_b32 v6, v6, v7, s[34:35]
    v_add_u32 v8, v6, v4
    s_add_u32 s28, s27, 2
    s_mul_i32 s29, s28, 7282
    s_lshr_b32 s29, s29, 16
    s_mul_i32 s36, s29, 9
    s_sub_u32 s36, s28, s36
    s_lshl_b32 s36, s36, 11
    s_lshl_b32 s29, s29, 8
    s_add_u32 s86, s29, s36
    s_add_u32 s28, s27, 3
    s_mul_i32 s29, s28, 7282
    s_lshr_b32 s29, s29, 16
    s_mul_i32 s36, s29, 9
    s_sub_u32 s36, s28, s36
    s_lshl_b32 s36, s36, 11
    s_lshl_b32 s29, s29, 8
    s_add_u32 s87, s29, s36
    v_mov_b32 v6, s87
    v_mov_b32 v7, s86
    v_cndmask_b32 v6, v6, v7, s[34:35]
    v_add_u32 v9, v6, v4
    s_add_u32 s28, s27, 4
    s_mul_i32 s29, s28, 7282
    s_lshr_b32 s29, s29, 16
    s_mul_i32 s36, s29, 9
    s_sub_u32 s36, s28, s36
    s_lshl_b32 s36, s36, 11
    s_lshl_b32 s29, s29, 8
    s_add_u32 s88, s29, s36
    s_add_u32 s28, s27, 5
    s_mul_i32 s29, s28, 7282
    s_lshr_b32 s29, s29, 16
    s_mul_i32 s36, s29, 9
    s_sub_u32 s36, s28, s36
    s_lshl_b32 s36, s36, 11
    s_lshl_b32 s29, s29, 8
    s_add_u32 s89, s29, s36
    v_mov_b32 v6, s89
    v_mov_b32 v7, s88
    v_cndmask_b32 v6, v6, v7, s[34:35]
    v_add_u32 v10, v6, v4
    v_pk_mul_f32 v[24:25], v[64:65], v[16:17]
    v_pk_mul_f32 v[26:27], v[66:67], v[16:17]
    v_pk_mul_f32 v[28:29], v[68:69], v[16:17]
    v_pk_mul_f32 v[30:31], v[70:71], v[16:17]
    v_pk_add_f32 v[64:65], v[64:65], v[18:19]
    v_pk_add_f32 v[66:67], v[66:67], v[18:19]
    v_exp_f32_e64 v24, v24 clamp
    v_exp_f32_e64 v25, v25 clamp
    v_exp_f32_e64 v26, v26 clamp
    v_exp_f32_e64 v27, v27 clamp
    v_pk_add_f32 v[68:69], v[68:69], v[18:19]
    v_pk_add_f32 v[70:71], v[70:71], v[18:19]
    v_exp_f32_e64 v28, v28 clamp
    v_exp_f32_e64 v29, v29 clamp
    v_exp_f32_e64 v30, v30 clamp
    v_exp_f32_e64 v31, v31 clamp
    v_pk_add_f32 v[24:25], v[24:25], v[20:21]
    v_pk_add_f32 v[26:27], v[26:27], v[20:21]
    v_max_f32 v64, v64, v24
    v_max_f32 v65, v65, v25
    v_pk_add_f32 v[28:29], v[28:29], v[20:21]
    v_pk_add_f32 v[30:31], v[30:31], v[20:21]
    v_max_f32 v66, v66, v26
    v_max_f32 v67, v67, v27
    v_max_f32 v68, v68, v28
    v_max_f32 v69, v69, v29
    v_max_f32 v70, v70, v30
    v_max_f32 v71, v71, v31
    v_cvt_pk_bf16_f32 v32, v64, v65
    v_cvt_pk_bf16_f32 v33, v66, v67
    v_cvt_pk_bf16_f32 v34, v68, v69
    v_cvt_pk_bf16_f32 v35, v70, v71
    v_pk_mul_f32 v[24:25], v[88:89], v[16:17]
    v_pk_mul_f32 v[26:27], v[90:91], v[16:17]
    v_pk_mul_f32 v[28:29], v[92:93], v[16:17]
    v_pk_mul_f32 v[30:31], v[94:95], v[16:17]
    v_permlane32_swap_b32 v32, v34
    v_permlane32_swap_b32 v33, v35
    v_pk_add_f32 v[88:89], v[88:89], v[18:19]
    v_pk_add_f32 v[90:91], v[90:91], v[18:19]
    v_exp_f32_e64 v24, v24 clamp
    v_exp_f32_e64 v25, v25 clamp
    v_exp_f32_e64 v26, v26 clamp
    v_exp_f32_e64 v27, v27 clamp
    v_permlane16_swap_b32 v32, v34
    v_permlane16_swap_b32 v33, v35
    v_pk_add_f32 v[92:93], v[92:93], v[18:19]
    v_pk_add_f32 v[94:95], v[94:95], v[18:19]
    v_exp_f32_e64 v28, v28 clamp
    v_exp_f32_e64 v29, v29 clamp
    v_exp_f32_e64 v30, v30 clamp
    v_exp_f32_e64 v31, v31 clamp
    s_add_u32 s26, s25, 0
    buffer_store_dwordx4 v[32:35], v8, s[12:15], s26 offen sc1
    v_pk_add_f32 v[24:25], v[24:25], v[20:21]
    v_pk_add_f32 v[26:27], v[26:27], v[20:21]
    v_max_f32 v88, v88, v24
    v_max_f32 v89, v89, v25
    v_pk_add_f32 v[28:29], v[28:29], v[20:21]
    v_pk_add_f32 v[30:31], v[30:31], v[20:21]
    v_max_f32 v90, v90, v26
    v_max_f32 v91, v91, v27
    v_max_f32 v92, v92, v28
    v_max_f32 v93, v93, v29
    v_max_f32 v94, v94, v30
    v_max_f32 v95, v95, v31
    v_cvt_pk_bf16_f32 v36, v88, v89
    v_cvt_pk_bf16_f32 v37, v90, v91
    v_cvt_pk_bf16_f32 v38, v92, v93
    v_cvt_pk_bf16_f32 v39, v94, v95
    v_pk_mul_f32 v[24:25], v[112:113], v[16:17]
    v_pk_mul_f32 v[26:27], v[114:115], v[16:17]
    v_pk_mul_f32 v[28:29], v[116:117], v[16:17]
    v_pk_mul_f32 v[30:31], v[118:119], v[16:17]
    v_permlane32_swap_b32 v36, v38
    v_permlane32_swap_b32 v37, v39
    v_pk_add_f32 v[112:113], v[112:113], v[18:19]
    v_pk_add_f32 v[114:115], v[114:115], v[18:19]
    v_exp_f32_e64 v24, v24 clamp
    v_exp_f32_e64 v25, v25 clamp
    v_exp_f32_e64 v26, v26 clamp
    v_exp_f32_e64 v27, v27 clamp
    v_permlane16_swap_b32 v36, v38
    v_permlane16_swap_b32 v37, v39
    v_pk_add_f32 v[116:117], v[116:117], v[18:19]
    v_pk_add_f32 v[118:119], v[118:119], v[18:19]
    v_exp_f32_e64 v28, v28 clamp
    v_exp_f32_e64 v29, v29 clamp
    v_exp_f32_e64 v30, v30 clamp
    v_exp_f32_e64 v31, v31 clamp
    s_add_u32 s26, s25, 18432
    buffer_store_dwordx4 v[36:39], v8, s[12:15], s26 offen sc1
    v_pk_add_f32 v[24:25], v[24:25], v[20:21]
    v_pk_add_f32 v[26:27], v[26:27], v[20:21]
    v_max_f32 v112, v112, v24
    v_max_f32 v113, v113, v25
    v_pk_add_f32 v[28:29], v[28:29], v[20:21]
    v_pk_add_f32 v[30:31], v[30:31], v[20:21]
    v_max_f32 v114, v114, v26
    v_max_f32 v115, v115, v27
    v_max_f32 v116, v116, v28
    v_max_f32 v117, v117, v29
    v_max_f32 v118, v118, v30
    v_max_f32 v119, v119, v31
    v_cvt_pk_bf16_f32 v40, v112, v113
    v_cvt_pk_bf16_f32 v41, v114, v115
    v_cvt_pk_bf16_f32 v42, v116, v117
    v_cvt_pk_bf16_f32 v43, v118, v119
    v_pk_mul_f32 v[24:25], v[136:137], v[16:17]
    v_pk_mul_f32 v[26:27], v[138:139], v[16:17]
    v_pk_mul_f32 v[28:29], v[140:141], v[16:17]
    v_pk_mul_f32 v[30:31], v[142:143], v[16:17]
    v_permlane32_swap_b32 v40, v42
    v_permlane32_swap_b32 v41, v43
    v_pk_add_f32 v[136:137], v[136:137], v[18:19]
    v_pk_add_f32 v[138:139], v[138:139], v[18:19]
    v_exp_f32_e64 v24, v24 clamp
    v_exp_f32_e64 v25, v25 clamp
    v_exp_f32_e64 v26, v26 clamp
    v_exp_f32_e64 v27, v27 clamp
    v_permlane16_swap_b32 v40, v42
    v_permlane16_swap_b32 v41, v43
    v_pk_add_f32 v[140:141], v[140:141], v[18:19]
    v_pk_add_f32 v[142:143], v[142:143], v[18:19]
    v_exp_f32_e64 v28, v28 clamp
    v_exp_f32_e64 v29, v29 clamp
    v_exp_f32_e64 v30, v30 clamp
    v_exp_f32_e64 v31, v31 clamp
    s_add_u32 s26, s25, 36864
    buffer_store_dwordx4 v[40:43], v8, s[12:15], s26 offen sc1
    v_pk_add_f32 v[24:25], v[24:25], v[20:21]
    v_pk_add_f32 v[26:27], v[26:27], v[20:21]
    v_max_f32 v136, v136, v24
    v_max_f32 v137, v137, v25
    v_pk_add_f32 v[28:29], v[28:29], v[20:21]
    v_pk_add_f32 v[30:31], v[30:31], v[20:21]
    v_max_f32 v138, v138, v26
    v_max_f32 v139, v139, v27
    v_max_f32 v140, v140, v28
    v_max_f32 v141, v141, v29
    v_max_f32 v142, v142, v30
    v_max_f32 v143, v143, v31
    v_cvt_pk_bf16_f32 v44, v136, v137
    v_cvt_pk_bf16_f32 v45, v138, v139
    v_cvt_pk_bf16_f32 v46, v140, v141
    v_cvt_pk_bf16_f32 v47, v142, v143
    v_pk_mul_f32 v[24:25], v[72:73], v[16:17]
    v_pk_mul_f32 v[26:27], v[74:75], v[16:17]
    v_pk_mul_f32 v[28:29], v[76:77], v[16:17]
    v_pk_mul_f32 v[30:31], v[78:79], v[16:17]
    v_permlane32_swap_b32 v44, v46
    v_permlane32_swap_b32 v45, v47
    v_pk_add_f32 v[72:73], v[72:73], v[18:19]
    v_pk_add_f32 v[74:75], v[74:75], v[18:19]
    v_exp_f32_e64 v24, v24 clamp
    v_exp_f32_e64 v25, v25 clamp
    v_exp_f32_e64 v26, v26 clamp
    v_exp_f32_e64 v27, v27 clamp
    v_permlane16_swap_b32 v44, v46
    v_permlane16_swap_b32 v45, v47
    v_pk_add_f32 v[76:77], v[76:77], v[18:19]
    v_pk_add_f32 v[78:79], v[78:79], v[18:19]
    v_exp_f32_e64 v28, v28 clamp
    v_exp_f32_e64 v29, v29 clamp
    v_exp_f32_e64 v30, v30 clamp
    v_exp_f32_e64 v31, v31 clamp
    s_add_u32 s26, s25, 55296
    buffer_store_dwordx4 v[44:47], v8, s[12:15], s26 offen sc1
    v_pk_add_f32 v[24:25], v[24:25], v[20:21]
    v_pk_add_f32 v[26:27], v[26:27], v[20:21]
    v_max_f32 v72, v72, v24
    v_max_f32 v73, v73, v25
    v_pk_add_f32 v[28:29], v[28:29], v[20:21]
    v_pk_add_f32 v[30:31], v[30:31], v[20:21]
    v_max_f32 v74, v74, v26
    v_max_f32 v75, v75, v27
    v_max_f32 v76, v76, v28
    v_max_f32 v77, v77, v29
    v_max_f32 v78, v78, v30
    v_max_f32 v79, v79, v31
    v_cvt_pk_bf16_f32 v32, v72, v73
    v_cvt_pk_bf16_f32 v33, v74, v75
    v_cvt_pk_bf16_f32 v34, v76, v77
    v_cvt_pk_bf16_f32 v35, v78, v79
    v_pk_mul_f32 v[24:25], v[96:97], v[16:17]
    v_pk_mul_f32 v[26:27], v[98:99], v[16:17]
    v_pk_mul_f32 v[28:29], v[100:101], v[16:17]
    v_pk_mul_f32 v[30:31], v[102:103], v[16:17]
    v_permlane32_swap_b32 v32, v34
    v_permlane32_swap_b32 v33, v35
    v_pk_add_f32 v[96:97], v[96:97], v[18:19]
    v_pk_add_f32 v[98:99], v[98:99], v[18:19]
    v_exp_f32_e64 v24, v24 clamp
    v_exp_f32_e64 v25, v25 clamp
    v_exp_f32_e64 v26, v26 clamp
    v_exp_f32_e64 v27, v27 clamp
    v_permlane16_swap_b32 v32, v34
    v_permlane16_swap_b32 v33, v35
    v_pk_add_f32 v[100:101], v[100:101], v[18:19]
    v_pk_add_f32 v[102:103], v[102:103], v[18:19]
    v_exp_f32_e64 v28, v28 clamp
    v_exp_f32_e64 v29, v29 clamp
    v_exp_f32_e64 v30, v30 clamp
    v_exp_f32_e64 v31, v31 clamp
    s_add_u32 s26, s25, 0
    buffer_store_dwordx4 v[32:35], v9, s[12:15], s26 offen sc1
    v_pk_add_f32 v[24:25], v[24:25], v[20:21]
    v_pk_add_f32 v[26:27], v[26:27], v[20:21]
    v_max_f32 v96, v96, v24
    v_max_f32 v97, v97, v25
    v_pk_add_f32 v[28:29], v[28:29], v[20:21]
    v_pk_add_f32 v[30:31], v[30:31], v[20:21]
    v_max_f32 v98, v98, v26
    v_max_f32 v99, v99, v27
    v_max_f32 v100, v100, v28
    v_max_f32 v101, v101, v29
    v_max_f32 v102, v102, v30
    v_max_f32 v103, v103, v31
    v_cvt_pk_bf16_f32 v36, v96, v97
    v_cvt_pk_bf16_f32 v37, v98, v99
    v_cvt_pk_bf16_f32 v38, v100, v101
    v_cvt_pk_bf16_f32 v39, v102, v103
    v_pk_mul_f32 v[24:25], v[120:121], v[16:17]
    v_pk_mul_f32 v[26:27], v[122:123], v[16:17]
    v_pk_mul_f32 v[28:29], v[124:125], v[16:17]
    v_pk_mul_f32 v[30:31], v[126:127], v[16:17]
    v_permlane32_swap_b32 v36, v38
    v_permlane32_swap_b32 v37, v39
    v_pk_add_f32 v[120:121], v[120:121], v[18:19]
    v_pk_add_f32 v[122:123], v[122:123], v[18:19]
    v_exp_f32_e64 v24, v24 clamp
    v_exp_f32_e64 v25, v25 clamp
    v_exp_f32_e64 v26, v26 clamp
    v_exp_f32_e64 v27, v27 clamp
    v_permlane16_swap_b32 v36, v38
    v_permlane16_swap_b32 v37, v39
    v_pk_add_f32 v[124:125], v[124:125], v[18:19]
    v_pk_add_f32 v[126:127], v[126:127], v[18:19]
    v_exp_f32_e64 v28, v28 clamp
    v_exp_f32_e64 v29, v29 clamp
    v_exp_f32_e64 v30, v30 clamp
    v_exp_f32_e64 v31, v31 clamp
    s_add_u32 s26, s25, 18432
    buffer_store_dwordx4 v[36:39], v9, s[12:15], s26 offen sc1
    v_pk_add_f32 v[24:25], v[24:25], v[20:21]
    v_pk_add_f32 v[26:27], v[26:27], v[20:21]
    v_max_f32 v120, v120, v24
    v_max_f32 v121, v121, v25
    v_pk_add_f32 v[28:29], v[28:29], v[20:21]
    v_pk_add_f32 v[30:31], v[30:31], v[20:21]
    v_max_f32 v122, v122, v26
    v_max_f32 v123, v123, v27
    v_max_f32 v124, v124, v28
    v_max_f32 v125, v125, v29
    v_max_f32 v126, v126, v30
    v_max_f32 v127, v127, v31
    v_cvt_pk_bf16_f32 v40, v120, v121
    v_cvt_pk_bf16_f32 v41, v122, v123
    v_cvt_pk_bf16_f32 v42, v124, v125
    v_cvt_pk_bf16_f32 v43, v126, v127
    v_pk_mul_f32 v[24:25], v[144:145], v[16:17]
    v_pk_mul_f32 v[26:27], v[146:147], v[16:17]
    v_pk_mul_f32 v[28:29], v[148:149], v[16:17]
    v_pk_mul_f32 v[30:31], v[150:151], v[16:17]
    v_permlane32_swap_b32 v40, v42
    v_permlane32_swap_b32 v41, v43
    v_pk_add_f32 v[144:145], v[144:145], v[18:19]
    v_pk_add_f32 v[146:147], v[146:147], v[18:19]
    v_exp_f32_e64 v24, v24 clamp
    v_exp_f32_e64 v25, v25 clamp
    v_exp_f32_e64 v26, v26 clamp
    v_exp_f32_e64 v27, v27 clamp
    v_permlane16_swap_b32 v40, v42
    v_permlane16_swap_b32 v41, v43
    v_pk_add_f32 v[148:149], v[148:149], v[18:19]
    v_pk_add_f32 v[150:151], v[150:151], v[18:19]
    v_exp_f32_e64 v28, v28 clamp
    v_exp_f32_e64 v29, v29 clamp
    v_exp_f32_e64 v30, v30 clamp
    v_exp_f32_e64 v31, v31 clamp
    s_add_u32 s26, s25, 36864
    buffer_store_dwordx4 v[40:43], v9, s[12:15], s26 offen sc1
    v_pk_add_f32 v[24:25], v[24:25], v[20:21]
    v_pk_add_f32 v[26:27], v[26:27], v[20:21]
    v_max_f32 v144, v144, v24
    v_max_f32 v145, v145, v25
    v_pk_add_f32 v[28:29], v[28:29], v[20:21]
    v_pk_add_f32 v[30:31], v[30:31], v[20:21]
    v_max_f32 v146, v146, v26
    v_max_f32 v147, v147, v27
    v_max_f32 v148, v148, v28
    v_max_f32 v149, v149, v29
    v_max_f32 v150, v150, v30
    v_max_f32 v151, v151, v31
    v_cvt_pk_bf16_f32 v44, v144, v145
    v_cvt_pk_bf16_f32 v45, v146, v147
    v_cvt_pk_bf16_f32 v46, v148, v149
    v_cvt_pk_bf16_f32 v47, v150, v151
    v_pk_mul_f32 v[24:25], v[80:81], v[16:17]
    v_pk_mul_f32 v[26:27], v[82:83], v[16:17]
    v_pk_mul_f32 v[28:29], v[84:85], v[16:17]
    v_pk_mul_f32 v[30:31], v[86:87], v[16:17]
    v_permlane32_swap_b32 v44, v46
    v_permlane32_swap_b32 v45, v47
    v_pk_add_f32 v[80:81], v[80:81], v[18:19]
    v_pk_add_f32 v[82:83], v[82:83], v[18:19]
    v_exp_f32_e64 v24, v24 clamp
    v_exp_f32_e64 v25, v25 clamp
    v_exp_f32_e64 v26, v26 clamp
    v_exp_f32_e64 v27, v27 clamp
    v_permlane16_swap_b32 v44, v46
    v_permlane16_swap_b32 v45, v47
    v_pk_add_f32 v[84:85], v[84:85], v[18:19]
    v_pk_add_f32 v[86:87], v[86:87], v[18:19]
    v_exp_f32_e64 v28, v28 clamp
    v_exp_f32_e64 v29, v29 clamp
    v_exp_f32_e64 v30, v30 clamp
    v_exp_f32_e64 v31, v31 clamp
    s_add_u32 s26, s25, 55296
    buffer_store_dwordx4 v[44:47], v9, s[12:15], s26 offen sc1
    v_pk_add_f32 v[24:25], v[24:25], v[20:21]
    v_pk_add_f32 v[26:27], v[26:27], v[20:21]
    v_max_f32 v80, v80, v24
    v_max_f32 v81, v81, v25
    v_pk_add_f32 v[28:29], v[28:29], v[20:21]
    v_pk_add_f32 v[30:31], v[30:31], v[20:21]
    v_max_f32 v82, v82, v26
    v_max_f32 v83, v83, v27
    v_max_f32 v84, v84, v28
    v_max_f32 v85, v85, v29
    v_max_f32 v86, v86, v30
    v_max_f32 v87, v87, v31
    v_cvt_pk_bf16_f32 v32, v80, v81
    v_cvt_pk_bf16_f32 v33, v82, v83
    v_cvt_pk_bf16_f32 v34, v84, v85
    v_cvt_pk_bf16_f32 v35, v86, v87
    v_pk_mul_f32 v[24:25], v[104:105], v[16:17]
    v_pk_mul_f32 v[26:27], v[106:107], v[16:17]
    v_pk_mul_f32 v[28:29], v[108:109], v[16:17]
    v_pk_mul_f32 v[30:31], v[110:111], v[16:17]
    v_permlane32_swap_b32 v32, v34
    v_permlane32_swap_b32 v33, v35
    v_pk_add_f32 v[104:105], v[104:105], v[18:19]
    v_pk_add_f32 v[106:107], v[106:107], v[18:19]
    v_exp_f32_e64 v24, v24 clamp
    v_exp_f32_e64 v25, v25 clamp
    v_exp_f32_e64 v26, v26 clamp
    v_exp_f32_e64 v27, v27 clamp
    v_permlane16_swap_b32 v32, v34
    v_permlane16_swap_b32 v33, v35
    v_pk_add_f32 v[108:109], v[108:109], v[18:19]
    v_pk_add_f32 v[110:111], v[110:111], v[18:19]
    v_exp_f32_e64 v28, v28 clamp
    v_exp_f32_e64 v29, v29 clamp
    v_exp_f32_e64 v30, v30 clamp
    v_exp_f32_e64 v31, v31 clamp
    s_add_u32 s26, s25, 0
    buffer_store_dwordx4 v[32:35], v10, s[12:15], s26 offen sc1
    v_pk_add_f32 v[24:25], v[24:25], v[20:21]
    v_pk_add_f32 v[26:27], v[26:27], v[20:21]
    v_max_f32 v104, v104, v24
    v_max_f32 v105, v105, v25
    v_pk_add_f32 v[28:29], v[28:29], v[20:21]
    v_pk_add_f32 v[30:31], v[30:31], v[20:21]
    v_max_f32 v106, v106, v26
    v_max_f32 v107, v107, v27
    v_max_f32 v108, v108, v28
    v_max_f32 v109, v109, v29
    v_max_f32 v110, v110, v30
    v_max_f32 v111, v111, v31
    v_cvt_pk_bf16_f32 v36, v104, v105
    v_cvt_pk_bf16_f32 v37, v106, v107
    v_cvt_pk_bf16_f32 v38, v108, v109
    v_cvt_pk_bf16_f32 v39, v110, v111
    v_pk_mul_f32 v[24:25], v[128:129], v[16:17]
    v_pk_mul_f32 v[26:27], v[130:131], v[16:17]
    v_pk_mul_f32 v[28:29], v[132:133], v[16:17]
    v_pk_mul_f32 v[30:31], v[134:135], v[16:17]
    v_permlane32_swap_b32 v36, v38
    v_permlane32_swap_b32 v37, v39
    v_pk_add_f32 v[128:129], v[128:129], v[18:19]
    v_pk_add_f32 v[130:131], v[130:131], v[18:19]
    v_exp_f32_e64 v24, v24 clamp
    v_exp_f32_e64 v25, v25 clamp
    v_exp_f32_e64 v26, v26 clamp
    v_exp_f32_e64 v27, v27 clamp
    v_permlane16_swap_b32 v36, v38
    v_permlane16_swap_b32 v37, v39
    v_pk_add_f32 v[132:133], v[132:133], v[18:19]
    v_pk_add_f32 v[134:135], v[134:135], v[18:19]
    v_exp_f32_e64 v28, v28 clamp
    v_exp_f32_e64 v29, v29 clamp
    v_exp_f32_e64 v30, v30 clamp
    v_exp_f32_e64 v31, v31 clamp
    s_add_u32 s26, s25, 18432
    buffer_store_dwordx4 v[36:39], v10, s[12:15], s26 offen sc1
    v_pk_add_f32 v[24:25], v[24:25], v[20:21]
    v_pk_add_f32 v[26:27], v[26:27], v[20:21]
    v_max_f32 v128, v128, v24
    v_max_f32 v129, v129, v25
    v_pk_add_f32 v[28:29], v[28:29], v[20:21]
    v_pk_add_f32 v[30:31], v[30:31], v[20:21]
    v_max_f32 v130, v130, v26
    v_max_f32 v131, v131, v27
    v_max_f32 v132, v132, v28
    v_max_f32 v133, v133, v29
    v_max_f32 v134, v134, v30
    v_max_f32 v135, v135, v31
    v_cvt_pk_bf16_f32 v40, v128, v129
    v_cvt_pk_bf16_f32 v41, v130, v131
    v_cvt_pk_bf16_f32 v42, v132, v133
    v_cvt_pk_bf16_f32 v43, v134, v135
    v_pk_mul_f32 v[24:25], v[152:153], v[16:17]
    v_pk_mul_f32 v[26:27], v[154:155], v[16:17]
    v_pk_mul_f32 v[28:29], v[156:157], v[16:17]
    v_pk_mul_f32 v[30:31], v[158:159], v[16:17]
    v_permlane32_swap_b32 v40, v42
    v_permlane32_swap_b32 v41, v43
    v_pk_add_f32 v[152:153], v[152:153], v[18:19]
    v_pk_add_f32 v[154:155], v[154:155], v[18:19]
    v_exp_f32_e64 v24, v24 clamp
    v_exp_f32_e64 v25, v25 clamp
    v_exp_f32_e64 v26, v26 clamp
    v_exp_f32_e64 v27, v27 clamp
    v_permlane16_swap_b32 v40, v42
    v_permlane16_swap_b32 v41, v43
    v_pk_add_f32 v[156:157], v[156:157], v[18:19]
    v_pk_add_f32 v[158:159], v[158:159], v[18:19]
    v_exp_f32_e64 v28, v28 clamp
    v_exp_f32_e64 v29, v29 clamp
    v_exp_f32_e64 v30, v30 clamp
    v_exp_f32_e64 v31, v31 clamp
    s_add_u32 s26, s25, 36864
    buffer_store_dwordx4 v[40:43], v10, s[12:15], s26 offen sc1
    v_pk_add_f32 v[24:25], v[24:25], v[20:21]
    v_pk_add_f32 v[26:27], v[26:27], v[20:21]
    v_max_f32 v152, v152, v24
    v_max_f32 v153, v153, v25
    v_pk_add_f32 v[28:29], v[28:29], v[20:21]
    v_pk_add_f32 v[30:31], v[30:31], v[20:21]
    v_max_f32 v154, v154, v26
    v_max_f32 v155, v155, v27
    v_max_f32 v156, v156, v28
    v_max_f32 v157, v157, v29
    v_max_f32 v158, v158, v30
    v_max_f32 v159, v159, v31
    v_cvt_pk_bf16_f32 v44, v152, v153
    v_cvt_pk_bf16_f32 v45, v154, v155
    v_cvt_pk_bf16_f32 v46, v156, v157
    v_cvt_pk_bf16_f32 v47, v158, v159
    s_nop 1
    v_permlane32_swap_b32 v44, v46
    v_permlane32_swap_b32 v45, v47
    s_nop 1
    v_permlane16_swap_b32 v44, v46
    v_permlane16_swap_b32 v45, v47
    s_nop 0
    s_add_u32 s26, s25, 55296
    buffer_store_dwordx4 v[44:47], v10, s[12:15], s26 offen sc1
    s_sub_u32 s20, s2, 32
    s_cmp_ge_u32 s2, 128
    s_cselect_b32 s20, s20, s2
    s_cmp_ge_u32 s20, 96
    s_cselect_b32 s21, 1, 0
    s_cmp_ge_u32 s2, 128
    s_cselect_b32 s21, 0, s21
    s_cmp_eq_u32 s21, 1
    s_cselect_b32 s65, 1, 0
    s_waitcnt vmcnt(0)
    v_and_b32 v12, 1, v1
    v_bfe_u32 v13, v1, 1, 2
    v_lshrrev_b32 v15, 3, v1
    v_and_b32 v15, 3, v15
    v_lshrrev_b32 v16, 5, v1
    v_and_b32 v17, 1, v13
    v_lshlrev_b32 v17, 10, v17
    v_lshl_add_u32 v17, v12, 7, v17
    v_mul_u32_u24 v15, 18432, v15
    v_add_u32 v17, v17, v15
    v_cmp_gt_u32 vcc, 2, v13
    v_mov_b32 v20, s85
    v_mov_b32 v21, s84
    v_cndmask_b32 v18, v20, v21, vcc
    v_mov_b32 v20, s87
    v_mov_b32 v21, s86
    v_cndmask_b32 v19, v20, v21, vcc
    v_cmp_eq_u32 s[34:35], 0, v16
    s_nop 1
    v_cndmask_b32 v18, v19, v18, s[34:35]
    v_add_u32 v18, v18, v17
    buffer_load_dword v253, v18, s[12:15], s25 offen
    v_mov_b32 v20, s89
    v_mov_b32 v21, s88
    v_cndmask_b32 v18, v20, v21, vcc
    v_mov_b32 v20, s89
    v_mov_b32 v21, s88
    v_cndmask_b32 v19, v20, v21, vcc
    v_cmp_eq_u32 s[34:35], 0, v16
    s_nop 1
    v_cndmask_b32 v18, v19, v18, s[34:35]
    v_add_u32 v18, v18, v17
    buffer_load_dword v253, v18, s[12:15], s25 offen
    s_barrier
    s_cmp_eq_u32 s3, 0
    s_cbranch_scc0 L_q_noflag
    v_readfirstlane_b32 s66, v14
    s_cmp_lg_u32 s66, 0
    s_cbranch_scc1 L_q_dbgok
    v_mov_b32 v244, 0
    s_mov_b32 s67, 0
L_wdbg_1:
    global_load_dword v245, v244, s[60:61] sc0 sc1
    s_waitcnt vmcnt(0)
    v_readfirstlane_b32 s66, v245
    s_cmp_lg_u32 s66, 0
    s_cbranch_scc1 L_wdbg_1_ok
    s_sleep 1
    s_add_u32 s67, s67, 1
    s_cmp_lt_u32 s67, 100000
    s_cbranch_scc1 L_wdbg_1
L_wdbg_1_ok:
L_q_dbgok:
    s_sub_u32 s21, s2, 48
    s_lshl_b32 s66, s21, 6
    s_add_u32 s66, s66, 7143424
    v_mov_b32 v244, s66
    v_mov_b32 v245, 1
    s_mov_b64 exec, 1
    global_store_dword v244, v245, s[62:63] sc0 sc1
    s_mov_b64 exec, -1
L_q_noflag:
    s_branch L_A_post
L_A_post:
    s_and_b32 s22, s20, 15
    s_lshr_b32 s23, s20, 4
    s_mov_b32 s12, s62
    s_and_b32 s13, s63, 0xffff
    s_mov_b32 s14, 8388608
    s_mov_b32 s15, 0x20000
    s_mov_b32 s28, s62
    s_and_b32 s29, s63, 0xffff
    s_mov_b32 s30, 7133184
    s_mov_b32 s31, 0x20000
    s_lshl_b32 s25, s22, 3
    s_add_u32 s25, s25, s3
    s_mul_i32 s25, s25, 18432
    s_add_u32 s25, s25, 4718592
    v_lshlrev_b32 v11, 4, v1
    s_waitcnt lgkmcnt(0)
    s_barrier
    ds_read_b64_tr_b16 v[16:17], v200 offset:0
    ds_read_b64_tr_b16 v[18:19], v204 offset:0
    ds_read_b64_tr_b16 v[20:21], v201 offset:0
    ds_read_b64_tr_b16 v[22:23], v205 offset:0
    ds_read_b64_tr_b16 v[24:25], v202 offset:0
    ds_read_b64_tr_b16 v[26:27], v206 offset:0
    ds_read_b64_tr_b16 v[28:29], v203 offset:0
    ds_read_b64_tr_b16 v[30:31], v207 offset:0
    ds_read_b64_tr_b16 v[32:33], v202 offset:18432
    ds_read_b64_tr_b16 v[34:35], v206 offset:18432
    ds_read_b64_tr_b16 v[36:37], v203 offset:18432
    ds_read_b64_tr_b16 v[38:39], v207 offset:18432
    s_waitcnt lgkmcnt(4)
    ds_read_b64_tr_b16 v[40:41], v200 offset:18432
    ds_read_b64_tr_b16 v[42:43], v204 offset:18432
    ds_read_b64_tr_b16 v[44:45], v201 offset:18432
    ds_read_b64_tr_b16 v[46:47], v205 offset:18432
    ds_read_b64_tr_b16 v[48:49], v200 offset:36864
    ds_read_b64_tr_b16 v[50:51], v204 offset:36864
    ds_read_b64_tr_b16 v[52:53], v201 offset:36864
    ds_read_b64_tr_b16 v[54:55], v205 offset:36864
    ds_read_b64_tr_b16 v[56:57], v202 offset:36864
    ds_read_b64_tr_b16 v[58:59], v206 offset:36864
    ds_read_b64_tr_b16 v[60:61], v203 offset:36864
    ds_read_b64_tr_b16 v[62:63], v207 offset:36864
    s_waitcnt lgkmcnt(4)
    ds_read_b64_tr_b16 v[64:65], v202 offset:55296
    ds_read_b64_tr_b16 v[66:67], v206 offset:55296
    ds_read_b64_tr_b16 v[68:69], v203 offset:55296
    ds_read_b64_tr_b16 v[70:71], v207 offset:55296
    ds_read_b64_tr_b16 v[72:73], v200 offset:55296
    ds_read_b64_tr_b16 v[74:75], v204 offset:55296
    ds_read_b64_tr_b16 v[76:77], v201 offset:55296
    ds_read_b64_tr_b16 v[78:79], v205 offset:55296
    s_cmp_eq_u32 s3, 0
    s_cbranch_scc0 L_g2_nopoll1
    v_min_u32 v250, 2, v1
    v_lshlrev_b32 v250, 4, v250
    s_lshr_b32 s66, s22, 3
    s_lshl_b32 s66, s66, 3
    s_and_b32 s67, s22, 7
    s_add_u32 s66, s66, s67
    s_add_u32 s66, s66, 80
    v_add_u32 v250, s66, v250
    v_lshlrev_b32 v250, 6, v250
    v_add_u32 v250, 7143424, v250
    s_mov_b32 s67, 0
L_poll_2:
    global_load_dword v246, v250, s[62:63] sc0 sc1
    s_waitcnt vmcnt(0)
    v_cmp_eq_u32 vcc, 0, v246
    s_nop 1
    s_cmp_eq_u64 vcc, 0
    s_cbranch_scc1 L_poll_2_ok
    s_sleep 1
    s_add_u32 s67, s67, 1
    s_cmp_lt_u32 s67, 100000
    s_cbranch_scc1 L_poll_2
L_poll_2_ok:
L_g2_nopoll1:
    s_barrier
    s_cmp_eq_u32 s3, 0
    s_cbranch_scc1 L_g2_poll2
    s_mov_b32 s91, s25
    buffer_load_dwordx4 v[128:131], v11, s[12:15], s25 offen offset:0 sc1
    buffer_load_dwordx4 v[132:135], v11, s[12:15], s25 offen offset:1024 sc1
    buffer_load_dwordx4 v[136:139], v11, s[12:15], s25 offen offset:2048 sc1
    buffer_load_dwordx4 v[140:143], v11, s[12:15], s25 offen offset:3072 sc1
    s_add_u32 s25, s25, 4096
    buffer_load_dwordx4 v[144:147], v11, s[12:15], s25 offen offset:0 sc1
    buffer_load_dwordx4 v[148:151], v11, s[12:15], s25 offen offset:1024 sc1
    buffer_load_dwordx4 v[152:155], v11, s[12:15], s25 offen offset:2048 sc1
    buffer_load_dwordx4 v[156:159], v11, s[12:15], s25 offen offset:3072 sc1
    s_add_u32 s25, s25, 4096
    s_branch L_g2_nopoll2
L_g2_poll2:
    v_lshlrev_b32 v251, 6, v1
    v_add_u32 v252, 7155712, v251
    v_add_u32 v251, 7151616, v251
    s_mov_b32 s67, 0
L_poll_3:
    global_load_dword v246, v251, s[62:63] sc0 sc1
    global_load_dword v247, v252, s[62:63] sc0 sc1
    s_waitcnt vmcnt(0)
    v_and_b32 v246, v246, v247
    v_cmp_eq_u32 vcc, 0, v246
    s_nop 1
    s_cmp_eq_u64 vcc, 0
    s_cbranch_scc1 L_poll_3_ok
    s_sleep 1
    s_add_u32 s67, s67, 1
    s_cmp_lt_u32 s67, 100000
    s_cbranch_scc1 L_poll_3
L_poll_3_ok:
L_g2_nopoll2:
    s_waitcnt lgkmcnt(0)
    s_barrier
    s_mov_b32 s26, 7077888
    buffer_load_dwordx4 v[80:83], v215, s[28:31], s26 offen sc1
    s_mov_b32 s26, 7086080
    buffer_load_dwordx4 v[84:87], v215, s[28:31], s26 offen sc1
    s_mov_b32 s26, 7094272
    buffer_load_dwordx4 v[88:91], v215, s[28:31], s26 offen sc1
    s_mov_b32 s26, 7102464
    buffer_load_dwordx4 v[92:95], v215, s[28:31], s26 offen sc1
    s_mov_b32 s26, 7110656
    buffer_load_dwordx4 v[96:99], v215, s[28:31], s26 offen sc1
    s_mov_b32 s26, 7118848
    buffer_load_dwordx4 v[100:103], v215, s[28:31], s26 offen sc1
    s_mov_b32 s26, 7127040
    buffer_load_dwordx4 v[104:107], v215, s[28:31], s26 offen sc1
    s_waitcnt vmcnt(6)
    v_cvt_pk_bf16_f32 v80, v80, v81
    v_cvt_pk_bf16_f32 v81, v82, v83
    s_andn2_b64 exec, -1, s[68:69]
    ds_write_b64 v224, v[80:81]
    s_mov_b64 exec, s[68:69]
    ds_write_b16 v224, v80
    s_mov_b64 exec, -1
    s_waitcnt vmcnt(5)
    v_cvt_pk_bf16_f32 v84, v84, v85
    v_cvt_pk_bf16_f32 v85, v86, v87
    s_andn2_b64 exec, -1, s[70:71]
    ds_write_b64 v225, v[84:85]
    s_mov_b64 exec, s[70:71]
    ds_write_b16 v225, v84
    s_mov_b64 exec, -1
    s_waitcnt vmcnt(4)
    v_cvt_pk_bf16_f32 v88, v88, v89
    v_cvt_pk_bf16_f32 v89, v90, v91
    s_andn2_b64 exec, -1, s[72:73]
    ds_write_b64 v226, v[88:89]
    s_mov_b64 exec, s[72:73]
    ds_write_b16 v226, v88
    s_mov_b64 exec, -1
    s_waitcnt vmcnt(3)
    v_cvt_pk_bf16_f32 v92, v92, v93
    v_cvt_pk_bf16_f32 v93, v94, v95
    s_andn2_b64 exec, -1, s[74:75]
    ds_write_b64 v227, v[92:93]
    s_mov_b64 exec, s[74:75]
    ds_write_b16 v227, v92
    s_mov_b64 exec, -1
    s_waitcnt vmcnt(2)
    v_cvt_pk_bf16_f32 v96, v96, v97
    v_cvt_pk_bf16_f32 v97, v98, v99
    s_andn2_b64 exec, -1, s[76:77]
    ds_write_b64 v228, v[96:97]
    s_mov_b64 exec, s[76:77]
    ds_write_b16 v228, v96
    s_mov_b64 exec, -1
    s_waitcnt vmcnt(1)
    v_cvt_pk_bf16_f32 v100, v100, v101
    v_cvt_pk_bf16_f32 v101, v102, v103
    s_andn2_b64 exec, -1, s[78:79]
    ds_write_b64 v229, v[100:101]
    s_mov_b64 exec, s[78:79]
    ds_write_b16 v229, v100
    s_mov_b64 exec, -1
    s_waitcnt vmcnt(0)
    v_cvt_pk_bf16_f32 v104, v104, v105
    v_cvt_pk_bf16_f32 v105, v106, v107
    s_movk_i32 s38, 384
    v_cmp_gt_u32 vcc, s38, v0
    s_nop 0
    s_and_b64 s[26:27], vcc, s[80:81]
    s_andn2_b64 exec, vcc, s[80:81]
    ds_write_b64 v230, v[104:105]
    s_mov_b64 exec, s[26:27]
    ds_write_b16 v230, v104
    s_mov_b64 exec, -1
    s_waitcnt lgkmcnt(0)
    s_barrier
    ds_read_b128 v[112:115], v216
    ds_read_b128 v[116:119], v220
    s_waitcnt lgkmcnt(0)
    v_mfma_f32_16x16x32_bf16 v[96:99], v[116:119], v[16:19], 0
    v_mfma_f32_16x16x32_bf16 v[100:103], v[116:119], v[20:23], 0
    v_mfma_f32_16x16x32_bf16 v[104:107], v[116:119], v[24:27], 0
    v_mfma_f32_16x16x32_bf16 v[108:111], v[116:119], v[28:31], 0
    v_mfma_f32_16x16x32_bf16 v[80:83], v[112:115], v[16:19], 0
    ds_read_b128 v[120:123], v217
    ds_read_b128 v[124:127], v221
    v_mfma_f32_16x16x32_bf16 v[84:87], v[112:115], v[20:23], 0
    v_mfma_f32_16x16x32_bf16 v[88:91], v[112:115], v[24:27], 0
    v_mfma_f32_16x16x32_bf16 v[92:95], v[112:115], v[28:31], 0
    s_waitcnt lgkmcnt(0)
    v_mfma_f32_16x16x32_bf16 v[96:99], v[124:127], v[32:35], v[96:99]
    v_mfma_f32_16x16x32_bf16 v[100:103], v[124:127], v[36:39], v[100:103]
    v_cvt_pk_bf16_f32 v80, v80, v81
    v_cvt_pk_bf16_f32 v81, v82, v83
    v_mfma_f32_16x16x32_bf16 v[104:107], v[124:127], v[40:43], v[104:107]
    v_cvt_pk_bf16_f32 v84, v84, v85
    v_cvt_pk_bf16_f32 v85, v86, v87
    ds_write2_b32 v208, v80, v81 offset0:0 offset1:1
    v_mfma_f32_16x16x32_bf16 v[108:111], v[124:127], v[44:47], v[108:111]
    v_cvt_pk_bf16_f32 v88, v88, v89
    v_cvt_pk_bf16_f32 v89, v90, v91
    ds_write2_b32 v209, v84, v85 offset0:0 offset1:1
    v_mfma_f32_16x16x32_bf16 v[80:83], v[120:123], v[32:35], 0
    v_cvt_pk_bf16_f32 v92, v92, v93
    v_cvt_pk_bf16_f32 v93, v94, v95
    ds_write2_b32 v210, v88, v89 offset0:0 offset1:1
    ds_read_b128 v[112:115], v218
    ds_read_b128 v[116:119], v222
    v_mfma_f32_16x16x32_bf16 v[84:87], v[120:123], v[36:39], 0
    ds_write2_b32 v211, v92, v93 offset0:0 offset1:1
    v_add_u32 v208, 19456, v208
    v_add_u32 v209, 19456, v209
    v_add_u32 v210, 19456, v210
    v_add_u32 v211, 19456, v211
    v_mfma_f32_16x16x32_bf16 v[88:91], v[120:123], v[40:43], 0
    v_mfma_f32_16x16x32_bf16 v[92:95], v[120:123], v[44:47], 0
    s_waitcnt lgkmcnt(1)
    v_mfma_f32_16x16x32_bf16 v[96:99], v[116:119], v[48:51], v[96:99]
    v_mfma_f32_16x16x32_bf16 v[100:103], v[116:119], v[52:55], v[100:103]
    v_cvt_pk_bf16_f32 v80, v80, v81
    v_cvt_pk_bf16_f32 v81, v82, v83
    v_mfma_f32_16x16x32_bf16 v[104:107], v[116:119], v[56:59], v[104:107]
    v_cvt_pk_bf16_f32 v84, v84, v85
    v_cvt_pk_bf16_f32 v85, v86, v87
    ds_write2_b32 v208, v80, v81 offset0:0 offset1:1
    v_mfma_f32_16x16x32_bf16 v[108:111], v[116:119], v[60:63], v[108:111]
    v_cvt_pk_bf16_f32 v88, v88, v89
    v_cvt_pk_bf16_f32 v89, v90, v91
    ds_write2_b32 v209, v84, v85 offset0:0 offset1:1
    v_mfma_f32_16x16x32_bf16 v[80:83], v[112:115], v[48:51], 0
    v_cvt_pk_bf16_f32 v92, v92, v93
    v_cvt_pk_bf16_f32 v93, v94, v95
    ds_write2_b32 v210, v88, v89 offset0:0 offset1:1
    ds_read_b128 v[120:123], v219
    ds_read_b128 v[124:127], v223
    v_mfma_f32_16x16x32_bf16 v[84:87], v[112:115], v[52:55], 0
    ds_write2_b32 v211, v92, v93 offset0:0 offset1:1
    v_add_u32 v208, 19456, v208
    v_add_u32 v209, 19456, v209
    v_add_u32 v210, 19456, v210
    v_add_u32 v211, 19456, v211
    v_mfma_f32_16x16x32_bf16 v[88:91], v[112:115], v[56:59], 0
    v_mfma_f32_16x16x32_bf16 v[92:95], v[112:115], v[60:63], 0
    s_waitcnt lgkmcnt(1)
    v_mfma_f32_16x16x32_bf16 v[96:99], v[124:127], v[64:67], v[96:99]
    v_mfma_f32_16x16x32_bf16 v[100:103], v[124:127], v[68:71], v[100:103]
    v_cvt_pk_bf16_f32 v80, v80, v81
    v_cvt_pk_bf16_f32 v81, v82, v83
    v_mfma_f32_16x16x32_bf16 v[104:107], v[124:127], v[72:75], v[104:107]
    v_cvt_pk_bf16_f32 v84, v84, v85
    v_cvt_pk_bf16_f32 v85, v86, v87
    ds_write2_b32 v208, v80, v81 offset0:0 offset1:1
    v_mfma_f32_16x16x32_bf16 v[108:111], v[124:127], v[76:79], v[108:111]
    v_cvt_pk_bf16_f32 v88, v88, v89
    v_cvt_pk_bf16_f32 v89, v90, v91
    ds_write2_b32 v209, v84, v85 offset0:0 offset1:1
    v_mfma_f32_16x16x32_bf16 v[80:83], v[120:123], v[64:67], 0
    v_cvt_pk_bf16_f32 v92, v92, v93
    v_cvt_pk_bf16_f32 v93, v94, v95
    ds_write2_b32 v210, v88, v89 offset0:0 offset1:1
    v_mfma_f32_16x16x32_bf16 v[84:87], v[120:123], v[68:71], 0
    ds_write2_b32 v211, v92, v93 offset0:0 offset1:1
    v_add_u32 v208, 19456, v208
    v_add_u32 v209, 19456, v209
    v_add_u32 v210, 19456, v210
    v_add_u32 v211, 19456, v211
    v_mfma_f32_16x16x32_bf16 v[88:91], v[120:123], v[72:75], 0
    v_mfma_f32_16x16x32_bf16 v[92:95], v[120:123], v[76:79], 0
    s_nop 7
    v_cvt_pk_bf16_f32 v80, v80, v81
    v_cvt_pk_bf16_f32 v81, v82, v83
    v_cvt_pk_bf16_f32 v84, v84, v85
    v_cvt_pk_bf16_f32 v85, v86, v87
    ds_write2_b32 v208, v80, v81 offset0:0 offset1:1
    v_cvt_pk_bf16_f32 v88, v88, v89
    v_cvt_pk_bf16_f32 v89, v90, v91
    ds_write2_b32 v209, v84, v85 offset0:0 offset1:1
    v_cvt_pk_bf16_f32 v92, v92, v93
    v_cvt_pk_bf16_f32 v93, v94, v95
    ds_write2_b32 v210, v88, v89 offset0:0 offset1:1
    ds_write2_b32 v211, v92, v93 offset0:0 offset1:1
    v_cvt_pk_bf16_f32 v96, v96, v97
    v_cvt_pk_bf16_f32 v100, v100, v101
    v_cvt_pk_bf16_f32 v104, v104, v105
    v_cvt_pk_bf16_f32 v108, v108, v109
    ds_write_b32 v212, v96 offset:0
    ds_write_b32 v212, v100 offset:4864
    ds_write_b32 v212, v104 offset:9728
    ds_write_b32 v212, v108 offset:14592
    s_cmp_eq_u32 s3, 0
    s_cbranch_scc0 L_g2_pqrest
    buffer_load_dwordx4 v[128:131], v11, s[12:15], s25 offen offset:0 sc1
    buffer_load_dwordx4 v[132:135], v11, s[12:15], s25 offen offset:1024 sc1
    buffer_load_dwordx4 v[136:139], v11, s[12:15], s25 offen offset:2048 sc1
    buffer_load_dwordx4 v[140:143], v11, s[12:15], s25 offen offset:3072 sc1
    s_add_u32 s25, s25, 4096
    buffer_load_dwordx4 v[144:147], v11, s[12:15], s25 offen offset:0 sc1
    buffer_load_dwordx4 v[148:151], v11, s[12:15], s25 offen offset:1024 sc1
    buffer_load_dwordx4 v[152:155], v11, s[12:15], s25 offen offset:2048 sc1
    buffer_load_dwordx4 v[156:159], v11, s[12:15], s25 offen offset:3072 sc1
    s_add_u32 s25, s25, 4096
L_g2_pqrest:
    buffer_load_dwordx4 v[160:163], v11, s[12:15], s25 offen offset:0 sc1
    buffer_load_dwordx4 v[164:167], v11, s[12:15], s25 offen offset:1024 sc1
    buffer_load_dwordx4 v[168:171], v11, s[12:15], s25 offen offset:2048 sc1
    buffer_load_dwordx4 v[172:175], v11, s[12:15], s25 offen offset:3072 sc1
    s_add_u32 s25, s25, 4096
    buffer_load_dwordx4 v[176:179], v11, s[12:15], s25 offen offset:0 sc1
    buffer_load_dwordx4 v[180:183], v11, s[12:15], s25 offen offset:1024 sc1
    buffer_load_dwordx4 v[184:187], v11, s[12:15], s25 offen offset:2048 sc1
    buffer_load_dwordx4 v[188:191], v11, s[12:15], s25 offen offset:3072 sc1
    s_add_u32 s25, s25, 4096
    buffer_load_dwordx4 v[192:195], v11, s[12:15], s25 offen offset:0 sc1
    buffer_load_dwordx4 v[196:199], v11, s[12:15], s25 offen offset:1024 sc1
    s_waitcnt lgkmcnt(0)
    ds_read_b128 v[32:35], v233 offset:0
    ds_read_b128 v[36:39], v233 offset:16
    ds_read_b128 v[40:43], v233 offset:32
    ds_read_b128 v[44:47], v233 offset:48
    ds_read_b128 v[48:51], v233 offset:64
    ds_read_b128 v[52:55], v233 offset:80
    ds_read_b128 v[56:59], v233 offset:96
    ds_read_b128 v[60:63], v233 offset:112
    ds_read_b128 v[64:67], v233 offset:128
    ds_read_b128 v[68:71], v234 offset:144
    ds_read_b128 v[72:75], v234 offset:160
    s_waitcnt vmcnt(17) lgkmcnt(10)
    v_mfma_f32_16x16x32_bf16 v[16:19], v[32:35], v[128:131], 0
    ds_read_b128 v[76:79], v234 offset:176
    s_waitcnt vmcnt(16) lgkmcnt(10)
    v_mfma_f32_16x16x32_bf16 v[16:19], v[36:39], v[132:135], v[16:19]
    ds_read_b128 v[32:35], v234 offset:192
    s_waitcnt vmcnt(15) lgkmcnt(10)
    v_mfma_f32_16x16x32_bf16 v[16:19], v[40:43], v[136:139], v[16:19]
    ds_read_b128 v[36:39], v234 offset:208
    s_waitcnt vmcnt(14) lgkmcnt(10)
    v_mfma_f32_16x16x32_bf16 v[16:19], v[44:47], v[140:143], v[16:19]
    ds_read_b128 v[40:43], v234 offset:224
    s_waitcnt vmcnt(13) lgkmcnt(10)
    v_mfma_f32_16x16x32_bf16 v[16:19], v[48:51], v[144:147], v[16:19]
    ds_read_b128 v[44:47], v234 offset:240
    s_waitcnt vmcnt(12) lgkmcnt(10)
    v_mfma_f32_16x16x32_bf16 v[16:19], v[52:55], v[148:151], v[16:19]
    ds_read_b128 v[48:51], v234 offset:256
    s_waitcnt vmcnt(11) lgkmcnt(10)
    v_mfma_f32_16x16x32_bf16 v[16:19], v[56:59], v[152:155], v[16:19]
    ds_read_b128 v[52:55], v234 offset:272
    s_waitcnt vmcnt(10) lgkmcnt(10)
    v_mfma_f32_16x16x32_bf16 v[16:19], v[60:63], v[156:159], v[16:19]
    s_waitcnt vmcnt(9) lgkmcnt(9)
    v_mfma_f32_16x16x32_bf16 v[16:19], v[64:67], v[160:163], v[16:19]
    s_waitcnt vmcnt(8) lgkmcnt(8)
    v_mfma_f32_16x16x32_bf16 v[20:23], v[68:71], v[164:167], 0
    s_waitcnt vmcnt(7) lgkmcnt(7)
    v_mfma_f32_16x16x32_bf16 v[20:23], v[72:75], v[168:171], v[20:23]
    s_waitcnt vmcnt(6) lgkmcnt(6)
    v_mfma_f32_16x16x32_bf16 v[20:23], v[76:79], v[172:175], v[20:23]
    s_waitcnt vmcnt(5) lgkmcnt(5)
    v_mfma_f32_16x16x32_bf16 v[20:23], v[32:35], v[176:179], v[20:23]
    s_waitcnt vmcnt(4) lgkmcnt(4)
    v_mfma_f32_16x16x32_bf16 v[20:23], v[36:39], v[180:183], v[20:23]
    s_waitcnt vmcnt(3) lgkmcnt(3)
    v_mfma_f32_16x16x32_bf16 v[20:23], v[40:43], v[184:187], v[20:23]
    s_waitcnt vmcnt(2) lgkmcnt(2)
    v_mfma_f32_16x16x32_bf16 v[20:23], v[44:47], v[188:191], v[20:23]
    s_waitcnt vmcnt(1) lgkmcnt(1)
    v_mfma_f32_16x16x32_bf16 v[20:23], v[48:51], v[192:195], v[20:23]
    s_waitcnt vmcnt(0) lgkmcnt(0)
    v_mfma_f32_16x16x32_bf16 v[20:23], v[52:55], v[196:199], v[20:23]
    s_nop 7
    v_add_f32 v24, 0x358637bd, v16
    v_add_f32 v25, 0x358637bd, v17
    v_add_f32 v26, 0x358637bd, v18
    v_add_f32 v27, 0x358637bd, v19
    v_add_f32 v28, 0x358637bd, v20
    v_add_f32 v29, 0x358637bd, v21
    v_add_f32 v30, 0x358637bd, v22
    v_add_f32 v31, 0x358637bd, v23
    v_rcp_f32 v24, v24
    v_rcp_f32 v25, v25
    v_rcp_f32 v26, v26
    v_rcp_f32 v27, v27
    v_rcp_f32 v28, v28
    v_rcp_f32 v29, v29
    v_rcp_f32 v30, v30
    v_rcp_f32 v31, v31
    v_mov_b32 v14, 0xffff0000
    v_lshlrev_b32 v32, 16, v128
    v_and_b32 v33, v14, v128
    v_pk_mul_f32 v[32:33], v[32:33], v[24:25] op_sel_hi:[1,0]
    v_lshlrev_b32 v34, 16, v129
    v_and_b32 v35, v14, v129
    v_pk_mul_f32 v[34:35], v[34:35], v[24:25] op_sel_hi:[1,0]
    v_lshlrev_b32 v36, 16, v130
    v_and_b32 v37, v14, v130
    v_pk_mul_f32 v[36:37], v[36:37], v[24:25] op_sel_hi:[1,0]
    v_lshlrev_b32 v38, 16, v131
    v_and_b32 v39, v14, v131
    v_pk_mul_f32 v[38:39], v[38:39], v[24:25] op_sel_hi:[1,0]
    v_cvt_pk_bf16_f32 v128, v32, v33
    v_cvt_pk_bf16_f32 v129, v34, v35
    v_cvt_pk_bf16_f32 v130, v36, v37
    v_cvt_pk_bf16_f32 v131, v38, v39
    v_lshlrev_b32 v32, 16, v132
    v_and_b32 v33, v14, v132
    v_pk_mul_f32 v[32:33], v[32:33], v[24:25] op_sel_hi:[1,0]
    v_lshlrev_b32 v34, 16, v133
    v_and_b32 v35, v14, v133
    v_pk_mul_f32 v[34:35], v[34:35], v[24:25] op_sel_hi:[1,0]
    v_lshlrev_b32 v36, 16, v134
    v_and_b32 v37, v14, v134
    v_pk_mul_f32 v[36:37], v[36:37], v[24:25] op_sel_hi:[1,0]
    v_lshlrev_b32 v38, 16, v135
    v_and_b32 v39, v14, v135
    v_pk_mul_f32 v[38:39], v[38:39], v[24:25] op_sel_hi:[1,0]
    v_cvt_pk_bf16_f32 v132, v32, v33
    v_cvt_pk_bf16_f32 v133, v34, v35
    v_cvt_pk_bf16_f32 v134, v36, v37
    v_cvt_pk_bf16_f32 v135, v38, v39
    v_lshlrev_b32 v32, 16, v136
    v_and_b32 v33, v14, v136
    v_pk_mul_f32 v[32:33], v[32:33], v[24:25] op_sel_hi:[1,0]
    v_lshlrev_b32 v34, 16, v137
    v_and_b32 v35, v14, v137
    v_pk_mul_f32 v[34:35], v[34:35], v[24:25] op_sel:[0,1] op_sel_hi:[1,1]
    v_lshlrev_b32 v36, 16, v138
    v_and_b32 v37, v14, v138
    v_pk_mul_f32 v[36:37], v[36:37], v[24:25] op_sel:[0,1] op_sel_hi:[1,1]
    v_lshlrev_b32 v38, 16, v139
    v_and_b32 v39, v14, v139
    v_pk_mul_f32 v[38:39], v[38:39], v[24:25] op_sel:[0,1] op_sel_hi:[1,1]
    v_cvt_pk_bf16_f32 v136, v32, v33
    v_cvt_pk_bf16_f32 v137, v34, v35
    v_cvt_pk_bf16_f32 v138, v36, v37
    v_cvt_pk_bf16_f32 v139, v38, v39
    v_lshlrev_b32 v32, 16, v140
    v_and_b32 v33, v14, v140
    v_pk_mul_f32 v[32:33], v[32:33], v[24:25] op_sel:[0,1] op_sel_hi:[1,1]
    v_lshlrev_b32 v34, 16, v141
    v_and_b32 v35, v14, v141
    v_pk_mul_f32 v[34:35], v[34:35], v[24:25] op_sel:[0,1] op_sel_hi:[1,1]
    v_lshlrev_b32 v36, 16, v142
    v_and_b32 v37, v14, v142
    v_pk_mul_f32 v[36:37], v[36:37], v[24:25] op_sel:[0,1] op_sel_hi:[1,1]
    v_lshlrev_b32 v38, 16, v143
    v_and_b32 v39, v14, v143
    v_pk_mul_f32 v[38:39], v[38:39], v[24:25] op_sel:[0,1] op_sel_hi:[1,1]
    v_cvt_pk_bf16_f32 v140, v32, v33
    v_cvt_pk_bf16_f32 v141, v34, v35
    v_cvt_pk_bf16_f32 v142, v36, v37
    v_cvt_pk_bf16_f32 v143, v38, v39
    v_lshlrev_b32 v32, 16, v144
    v_and_b32 v33, v14, v144
    v_pk_mul_f32 v[32:33], v[32:33], v[24:25] op_sel:[0,1] op_sel_hi:[1,1]
    v_lshlrev_b32 v34, 16, v145
    v_and_b32 v35, v14, v145
    v_pk_mul_f32 v[34:35], v[34:35], v[24:25] op_sel:[0,1] op_sel_hi:[1,1]
    v_lshlrev_b32 v36, 16, v146
    v_and_b32 v37, v14, v146
    v_pk_mul_f32 v[36:37], v[36:37], v[26:27] op_sel_hi:[1,0]
    v_lshlrev_b32 v38, 16, v147
    v_and_b32 v39, v14, v147
    v_pk_mul_f32 v[38:39], v[38:39], v[26:27] op_sel_hi:[1,0]
    v_cvt_pk_bf16_f32 v144, v32, v33
    v_cvt_pk_bf16_f32 v145, v34, v35
    v_cvt_pk_bf16_f32 v146, v36, v37
    v_cvt_pk_bf16_f32 v147, v38, v39
    v_lshlrev_b32 v32, 16, v148
    v_and_b32 v33, v14, v148
    v_pk_mul_f32 v[32:33], v[32:33], v[26:27] op_sel_hi:[1,0]
    v_lshlrev_b32 v34, 16, v149
    v_and_b32 v35, v14, v149
    v_pk_mul_f32 v[34:35], v[34:35], v[26:27] op_sel_hi:[1,0]
    v_lshlrev_b32 v36, 16, v150
    v_and_b32 v37, v14, v150
    v_pk_mul_f32 v[36:37], v[36:37], v[26:27] op_sel_hi:[1,0]
    v_lshlrev_b32 v38, 16, v151
    v_and_b32 v39, v14, v151
    v_pk_mul_f32 v[38:39], v[38:39], v[26:27] op_sel_hi:[1,0]
    v_cvt_pk_bf16_f32 v148, v32, v33
    v_cvt_pk_bf16_f32 v149, v34, v35
    v_cvt_pk_bf16_f32 v150, v36, v37
    v_cvt_pk_bf16_f32 v151, v38, v39
    v_lshlrev_b32 v32, 16, v152
    v_and_b32 v33, v14, v152
    v_pk_mul_f32 v[32:33], v[32:33], v[26:27] op_sel_hi:[1,0]
    v_lshlrev_b32 v34, 16, v153
    v_and_b32 v35, v14, v153
    v_pk_mul_f32 v[34:35], v[34:35], v[26:27] op_sel_hi:[1,0]
    v_lshlrev_b32 v36, 16, v154
    v_and_b32 v37, v14, v154
    v_pk_mul_f32 v[36:37], v[36:37], v[26:27] op_sel_hi:[1,0]
    v_lshlrev_b32 v38, 16, v155
    v_and_b32 v39, v14, v155
    v_pk_mul_f32 v[38:39], v[38:39], v[26:27] op_sel:[0,1] op_sel_hi:[1,1]
    v_cvt_pk_bf16_f32 v152, v32, v33
    v_cvt_pk_bf16_f32 v153, v34, v35
    v_cvt_pk_bf16_f32 v154, v36, v37
    v_cvt_pk_bf16_f32 v155, v38, v39
    v_lshlrev_b32 v32, 16, v156
    v_and_b32 v33, v14, v156
    v_pk_mul_f32 v[32:33], v[32:33], v[26:27] op_sel:[0,1] op_sel_hi:[1,1]
    v_lshlrev_b32 v34, 16, v157
    v_and_b32 v35, v14, v157
    v_pk_mul_f32 v[34:35], v[34:35], v[26:27] op_sel:[0,1] op_sel_hi:[1,1]
    v_lshlrev_b32 v36, 16, v158
    v_and_b32 v37, v14, v158
    v_pk_mul_f32 v[36:37], v[36:37], v[26:27] op_sel:[0,1] op_sel_hi:[1,1]
    v_lshlrev_b32 v38, 16, v159
    v_and_b32 v39, v14, v159
    v_pk_mul_f32 v[38:39], v[38:39], v[26:27] op_sel:[0,1] op_sel_hi:[1,1]
    v_cvt_pk_bf16_f32 v156, v32, v33
    v_cvt_pk_bf16_f32 v157, v34, v35
    v_cvt_pk_bf16_f32 v158, v36, v37
    v_cvt_pk_bf16_f32 v159, v38, v39
    v_lshlrev_b32 v32, 16, v160
    v_and_b32 v33, v14, v160
    v_pk_mul_f32 v[32:33], v[32:33], v[26:27] op_sel:[0,1] op_sel_hi:[1,1]
    v_lshlrev_b32 v34, 16, v161
    v_and_b32 v35, v14, v161
    v_pk_mul_f32 v[34:35], v[34:35], v[26:27] op_sel:[0,1] op_sel_hi:[1,1]
    v_lshlrev_b32 v36, 16, v162
    v_and_b32 v37, v14, v162
    v_pk_mul_f32 v[36:37], v[36:37], v[26:27] op_sel:[0,1] op_sel_hi:[1,1]
    v_lshlrev_b32 v38, 16, v163
    v_and_b32 v39, v14, v163
    v_pk_mul_f32 v[38:39], v[38:39], v[26:27] op_sel:[0,1] op_sel_hi:[1,1]
    v_cvt_pk_bf16_f32 v160, v32, v33
    v_cvt_pk_bf16_f32 v161, v34, v35
    v_cvt_pk_bf16_f32 v162, v36, v37
    v_cvt_pk_bf16_f32 v163, v38, v39
    v_lshlrev_b32 v32, 16, v164
    v_and_b32 v33, v14, v164
    v_pk_mul_f32 v[32:33], v[32:33], v[28:29] op_sel_hi:[1,0]
    v_lshlrev_b32 v34, 16, v165
    v_and_b32 v35, v14, v165
    v_pk_mul_f32 v[34:35], v[34:35], v[28:29] op_sel_hi:[1,0]
    v_lshlrev_b32 v36, 16, v166
    v_and_b32 v37, v14, v166
    v_pk_mul_f32 v[36:37], v[36:37], v[28:29] op_sel_hi:[1,0]
    v_lshlrev_b32 v38, 16, v167
    v_and_b32 v39, v14, v167
    v_pk_mul_f32 v[38:39], v[38:39], v[28:29] op_sel_hi:[1,0]
    v_cvt_pk_bf16_f32 v164, v32, v33
    v_cvt_pk_bf16_f32 v165, v34, v35
    v_cvt_pk_bf16_f32 v166, v36, v37
    v_cvt_pk_bf16_f32 v167, v38, v39
    v_lshlrev_b32 v32, 16, v168
    v_and_b32 v33, v14, v168
    v_pk_mul_f32 v[32:33], v[32:33], v[28:29] op_sel_hi:[1,0]
    v_lshlrev_b32 v34, 16, v169
    v_and_b32 v35, v14, v169
    v_pk_mul_f32 v[34:35], v[34:35], v[28:29] op_sel_hi:[1,0]
    v_lshlrev_b32 v36, 16, v170
    v_and_b32 v37, v14, v170
    v_pk_mul_f32 v[36:37], v[36:37], v[28:29] op_sel_hi:[1,0]
    v_lshlrev_b32 v38, 16, v171
    v_and_b32 v39, v14, v171
    v_pk_mul_f32 v[38:39], v[38:39], v[28:29] op_sel_hi:[1,0]
    v_cvt_pk_bf16_f32 v168, v32, v33
    v_cvt_pk_bf16_f32 v169, v34, v35
    v_cvt_pk_bf16_f32 v170, v36, v37
    v_cvt_pk_bf16_f32 v171, v38, v39
    v_lshlrev_b32 v32, 16, v172
    v_and_b32 v33, v14, v172
    v_pk_mul_f32 v[32:33], v[32:33], v[28:29] op_sel_hi:[1,0]
    v_lshlrev_b32 v34, 16, v173
    v_and_b32 v35, v14, v173
    v_pk_mul_f32 v[34:35], v[34:35], v[28:29] op_sel:[0,1] op_sel_hi:[1,1]
    v_lshlrev_b32 v36, 16, v174
    v_and_b32 v37, v14, v174
    v_pk_mul_f32 v[36:37], v[36:37], v[28:29] op_sel:[0,1] op_sel_hi:[1,1]
    v_lshlrev_b32 v38, 16, v175
    v_and_b32 v39, v14, v175
    v_pk_mul_f32 v[38:39], v[38:39], v[28:29] op_sel:[0,1] op_sel_hi:[1,1]
    v_cvt_pk_bf16_f32 v172, v32, v33
    v_cvt_pk_bf16_f32 v173, v34, v35
    v_cvt_pk_bf16_f32 v174, v36, v37
    v_cvt_pk_bf16_f32 v175, v38, v39
    v_lshlrev_b32 v32, 16, v176
    v_and_b32 v33, v14, v176
    v_pk_mul_f32 v[32:33], v[32:33], v[28:29] op_sel:[0,1] op_sel_hi:[1,1]
    v_lshlrev_b32 v34, 16, v177
    v_and_b32 v35, v14, v177
    v_pk_mul_f32 v[34:35], v[34:35], v[28:29] op_sel:[0,1] op_sel_hi:[1,1]
    v_lshlrev_b32 v36, 16, v178
    v_and_b32 v37, v14, v178
    v_pk_mul_f32 v[36:37], v[36:37], v[28:29] op_sel:[0,1] op_sel_hi:[1,1]
    v_lshlrev_b32 v38, 16, v179
    v_and_b32 v39, v14, v179
    v_pk_mul_f32 v[38:39], v[38:39], v[28:29] op_sel:[0,1] op_sel_hi:[1,1]
    v_cvt_pk_bf16_f32 v176, v32, v33
    v_cvt_pk_bf16_f32 v177, v34, v35
    v_cvt_pk_bf16_f32 v178, v36, v37
    v_cvt_pk_bf16_f32 v179, v38, v39
    v_lshlrev_b32 v32, 16, v180
    v_and_b32 v33, v14, v180
    v_pk_mul_f32 v[32:33], v[32:33], v[28:29] op_sel:[0,1] op_sel_hi:[1,1]
    v_lshlrev_b32 v34, 16, v181
    v_and_b32 v35, v14, v181
    v_pk_mul_f32 v[34:35], v[34:35], v[28:29] op_sel:[0,1] op_sel_hi:[1,1]
    v_lshlrev_b32 v36, 16, v182
    v_and_b32 v37, v14, v182
    v_pk_mul_f32 v[36:37], v[36:37], v[30:31] op_sel_hi:[1,0]
    v_lshlrev_b32 v38, 16, v183
    v_and_b32 v39, v14, v183
    v_pk_mul_f32 v[38:39], v[38:39], v[30:31] op_sel_hi:[1,0]
    v_cvt_pk_bf16_f32 v180, v32, v33
    v_cvt_pk_bf16_f32 v181, v34, v35
    v_cvt_pk_bf16_f32 v182, v36, v37
    v_cvt_pk_bf16_f32 v183, v38, v39
    v_lshlrev_b32 v32, 16, v184
    v_and_b32 v33, v14, v184
    v_pk_mul_f32 v[32:33], v[32:33], v[30:31] op_sel_hi:[1,0]
    v_lshlrev_b32 v34, 16, v185
    v_and_b32 v35, v14, v185
    v_pk_mul_f32 v[34:35], v[34:35], v[30:31] op_sel_hi:[1,0]
    v_lshlrev_b32 v36, 16, v186
    v_and_b32 v37, v14, v186
    v_pk_mul_f32 v[36:37], v[36:37], v[30:31] op_sel_hi:[1,0]
    v_lshlrev_b32 v38, 16, v187
    v_and_b32 v39, v14, v187
    v_pk_mul_f32 v[38:39], v[38:39], v[30:31] op_sel_hi:[1,0]
    v_cvt_pk_bf16_f32 v184, v32, v33
    v_cvt_pk_bf16_f32 v185, v34, v35
    v_cvt_pk_bf16_f32 v186, v36, v37
    v_cvt_pk_bf16_f32 v187, v38, v39
    v_lshlrev_b32 v32, 16, v188
    v_and_b32 v33, v14, v188
    v_pk_mul_f32 v[32:33], v[32:33], v[30:31] op_sel_hi:[1,0]
    v_lshlrev_b32 v34, 16, v189
    v_and_b32 v35, v14, v189
    v_pk_mul_f32 v[34:35], v[34:35], v[30:31] op_sel_hi:[1,0]
    v_lshlrev_b32 v36, 16, v190
    v_and_b32 v37, v14, v190
    v_pk_mul_f32 v[36:37], v[36:37], v[30:31] op_sel_hi:[1,0]
    v_lshlrev_b32 v38, 16, v191
    v_and_b32 v39, v14, v191
    v_pk_mul_f32 v[38:39], v[38:39], v[30:31] op_sel:[0,1] op_sel_hi:[1,1]
    v_cvt_pk_bf16_f32 v188, v32, v33
    v_cvt_pk_bf16_f32 v189, v34, v35
    v_cvt_pk_bf16_f32 v190, v36, v37
    v_cvt_pk_bf16_f32 v191, v38, v39
    v_lshlrev_b32 v32, 16, v192
    v_and_b32 v33, v14, v192
    v_pk_mul_f32 v[32:33], v[32:33], v[30:31] op_sel:[0,1] op_sel_hi:[1,1]
    v_lshlrev_b32 v34, 16, v193
    v_and_b32 v35, v14, v193
    v_pk_mul_f32 v[34:35], v[34:35], v[30:31] op_sel:[0,1] op_sel_hi:[1,1]
    v_lshlrev_b32 v36, 16, v194
    v_and_b32 v37, v14, v194
    v_pk_mul_f32 v[36:37], v[36:37], v[30:31] op_sel:[0,1] op_sel_hi:[1,1]
    v_lshlrev_b32 v38, 16, v195
    v_and_b32 v39, v14, v195
    v_pk_mul_f32 v[38:39], v[38:39], v[30:31] op_sel:[0,1] op_sel_hi:[1,1]
    v_cvt_pk_bf16_f32 v192, v32, v33
    v_cvt_pk_bf16_f32 v193, v34, v35
    v_cvt_pk_bf16_f32 v194, v36, v37
    v_cvt_pk_bf16_f32 v195, v38, v39
    v_lshlrev_b32 v32, 16, v196
    v_and_b32 v33, v14, v196
    v_pk_mul_f32 v[32:33], v[32:33], v[30:31] op_sel:[0,1] op_sel_hi:[1,1]
    v_lshlrev_b32 v34, 16, v197
    v_and_b32 v35, v14, v197
    v_pk_mul_f32 v[34:35], v[34:35], v[30:31] op_sel:[0,1] op_sel_hi:[1,1]
    v_lshlrev_b32 v36, 16, v198
    v_and_b32 v37, v14, v198
    v_pk_mul_f32 v[36:37], v[36:37], v[30:31] op_sel:[0,1] op_sel_hi:[1,1]
    v_lshlrev_b32 v38, 16, v199
    v_and_b32 v39, v14, v199
    v_pk_mul_f32 v[38:39], v[38:39], v[30:31] op_sel:[0,1] op_sel_hi:[1,1]
    v_cvt_pk_bf16_f32 v196, v32, v33
    v_cvt_pk_bf16_f32 v197, v34, v35
    v_cvt_pk_bf16_f32 v198, v36, v37
    v_cvt_pk_bf16_f32 v199, v38, v39
    s_waitcnt lgkmcnt(0)
    s_barrier
    s_mov_b32 s16, s58
    s_and_b32 s17, s59, 0xffff
    s_mov_b32 s18, 4718592
    s_mov_b32 s19, 0x20000
    s_lshl_b32 s25, s22, 7
    s_lshl_b32 s26, s3, 4
    s_add_u32 s25, s25, s26
    s_mul_i32 s25, s25, 2304
    s_lshl_b32 s26, s23, 7
    s_add_u32 s25, s25, s26
    v_mul_u32_u24 v12, 2304, v213
    v_lshl_add_u32 v12, v214, 4, v12
    ds_read_b128 v[64:67], v235 offset:0
    ds_read_b128 v[68:71], v235 offset:4864
    ds_read_b128 v[72:75], v235 offset:9728
    ds_read_b128 v[76:79], v235 offset:14592
    ds_read_b128 v[80:83], v235 offset:16
    ds_read_b128 v[84:87], v235 offset:4880
    ds_read_b128 v[88:91], v235 offset:9744
    ds_read_b128 v[92:95], v235 offset:14608
    ds_read_b128 v[96:99], v235 offset:32
    ds_read_b128 v[100:103], v235 offset:4896
    s_waitcnt lgkmcnt(8)
    v_mfma_f32_16x16x32_bf16 v[16:19], v[64:67], v[128:131], 0
    ds_read_b128 v[104:107], v235 offset:9760
    v_mfma_f32_16x16x32_bf16 v[20:23], v[68:71], v[128:131], 0
    ds_read_b128 v[108:111], v235 offset:14624
    s_waitcnt lgkmcnt(8)
    v_mfma_f32_16x16x32_bf16 v[24:27], v[72:75], v[128:131], 0
    ds_read_b128 v[112:115], v235 offset:48
    v_mfma_f32_16x16x32_bf16 v[28:31], v[76:79], v[128:131], 0
    ds_read_b128 v[116:119], v235 offset:4912
    s_waitcnt lgkmcnt(8)
    v_mfma_f32_16x16x32_bf16 v[16:19], v[80:83], v[132:135], v[16:19]
    ds_read_b128 v[120:123], v235 offset:9776
    v_mfma_f32_16x16x32_bf16 v[20:23], v[84:87], v[132:135], v[20:23]
    ds_read_b128 v[124:127], v235 offset:14640
    s_waitcnt lgkmcnt(8)
    v_mfma_f32_16x16x32_bf16 v[24:27], v[88:91], v[132:135], v[24:27]
    ds_read_b128 v[64:67], v235 offset:64
    v_mfma_f32_16x16x32_bf16 v[28:31], v[92:95], v[132:135], v[28:31]
    ds_read_b128 v[68:71], v235 offset:4928
    s_waitcnt lgkmcnt(8)
    v_mfma_f32_16x16x32_bf16 v[16:19], v[96:99], v[136:139], v[16:19]
    ds_read_b128 v[72:75], v235 offset:9792
    v_mfma_f32_16x16x32_bf16 v[20:23], v[100:103], v[136:139], v[20:23]
    ds_read_b128 v[76:79], v235 offset:14656
    s_waitcnt lgkmcnt(8)
    v_mfma_f32_16x16x32_bf16 v[24:27], v[104:107], v[136:139], v[24:27]
    ds_read_b128 v[80:83], v235 offset:80
    v_mfma_f32_16x16x32_bf16 v[28:31], v[108:111], v[136:139], v[28:31]
    ds_read_b128 v[84:87], v235 offset:4944
    s_waitcnt lgkmcnt(8)
    v_mfma_f32_16x16x32_bf16 v[16:19], v[112:115], v[140:143], v[16:19]
    ds_read_b128 v[88:91], v235 offset:9808
    v_mfma_f32_16x16x32_bf16 v[20:23], v[116:119], v[140:143], v[20:23]
    ds_read_b128 v[92:95], v235 offset:14672
    s_waitcnt lgkmcnt(8)
    v_mfma_f32_16x16x32_bf16 v[24:27], v[120:123], v[140:143], v[24:27]
    ds_read_b128 v[96:99], v235 offset:96
    v_mfma_f32_16x16x32_bf16 v[28:31], v[124:127], v[140:143], v[28:31]
    ds_read_b128 v[100:103], v235 offset:4960
    s_waitcnt lgkmcnt(8)
    v_mfma_f32_16x16x32_bf16 v[16:19], v[64:67], v[144:147], v[16:19]
    ds_read_b128 v[104:107], v235 offset:9824
    v_mfma_f32_16x16x32_bf16 v[20:23], v[68:71], v[144:147], v[20:23]
    ds_read_b128 v[108:111], v235 offset:14688
    s_waitcnt lgkmcnt(8)
    v_mfma_f32_16x16x32_bf16 v[24:27], v[72:75], v[144:147], v[24:27]
    ds_read_b128 v[112:115], v235 offset:112
    v_mfma_f32_16x16x32_bf16 v[28:31], v[76:79], v[144:147], v[28:31]
    ds_read_b128 v[116:119], v235 offset:4976
    s_waitcnt lgkmcnt(8)
    v_mfma_f32_16x16x32_bf16 v[16:19], v[80:83], v[148:151], v[16:19]
    ds_read_b128 v[120:123], v235 offset:9840
    v_mfma_f32_16x16x32_bf16 v[20:23], v[84:87], v[148:151], v[20:23]
    ds_read_b128 v[124:127], v235 offset:14704
    s_waitcnt lgkmcnt(8)
    v_mfma_f32_16x16x32_bf16 v[24:27], v[88:91], v[148:151], v[24:27]
    ds_read_b128 v[64:67], v235 offset:128
    v_mfma_f32_16x16x32_bf16 v[28:31], v[92:95], v[148:151], v[28:31]
    ds_read_b128 v[68:71], v235 offset:4992
    s_waitcnt lgkmcnt(8)
    v_mfma_f32_16x16x32_bf16 v[16:19], v[96:99], v[152:155], v[16:19]
    ds_read_b128 v[72:75], v235 offset:9856
    v_mfma_f32_16x16x32_bf16 v[20:23], v[100:103], v[152:155], v[20:23]
    ds_read_b128 v[76:79], v235 offset:14720
    s_waitcnt lgkmcnt(8)
    v_mfma_f32_16x16x32_bf16 v[24:27], v[104:107], v[152:155], v[24:27]
    ds_read_b128 v[80:83], v235 offset:144
    v_mfma_f32_16x16x32_bf16 v[28:31], v[108:111], v[152:155], v[28:31]
    ds_read_b128 v[84:87], v235 offset:5008
    s_waitcnt lgkmcnt(8)
    v_mfma_f32_16x16x32_bf16 v[16:19], v[112:115], v[156:159], v[16:19]
    ds_read_b128 v[88:91], v235 offset:9872
    v_mfma_f32_16x16x32_bf16 v[20:23], v[116:119], v[156:159], v[20:23]
    ds_read_b128 v[92:95], v235 offset:14736
    s_waitcnt lgkmcnt(8)
    v_mfma_f32_16x16x32_bf16 v[24:27], v[120:123], v[156:159], v[24:27]
    ds_read_b128 v[96:99], v235 offset:160
    v_mfma_f32_16x16x32_bf16 v[28:31], v[124:127], v[156:159], v[28:31]
    ds_read_b128 v[100:103], v235 offset:5024
    s_waitcnt lgkmcnt(8)
    v_mfma_f32_16x16x32_bf16 v[16:19], v[64:67], v[160:163], v[16:19]
    ds_read_b128 v[104:107], v235 offset:9888
    v_mfma_f32_16x16x32_bf16 v[20:23], v[68:71], v[160:163], v[20:23]
    ds_read_b128 v[108:111], v235 offset:14752
    s_waitcnt lgkmcnt(8)
    v_mfma_f32_16x16x32_bf16 v[24:27], v[72:75], v[160:163], v[24:27]
    ds_read_b128 v[112:115], v235 offset:176
    v_mfma_f32_16x16x32_bf16 v[28:31], v[76:79], v[160:163], v[28:31]
    ds_read_b128 v[116:119], v235 offset:5040
    s_waitcnt lgkmcnt(8)
    v_mfma_f32_16x16x32_bf16 v[16:19], v[80:83], v[164:167], v[16:19]
    ds_read_b128 v[120:123], v235 offset:9904
    v_mfma_f32_16x16x32_bf16 v[20:23], v[84:87], v[164:167], v[20:23]
    ds_read_b128 v[124:127], v235 offset:14768
    s_waitcnt lgkmcnt(8)
    v_mfma_f32_16x16x32_bf16 v[24:27], v[88:91], v[164:167], v[24:27]
    ds_read_b128 v[64:67], v235 offset:192
    v_mfma_f32_16x16x32_bf16 v[28:31], v[92:95], v[164:167], v[28:31]
    ds_read_b128 v[68:71], v235 offset:5056
    s_waitcnt lgkmcnt(8)
    v_mfma_f32_16x16x32_bf16 v[16:19], v[96:99], v[168:171], v[16:19]
    ds_read_b128 v[72:75], v235 offset:9920
    v_mfma_f32_16x16x32_bf16 v[20:23], v[100:103], v[168:171], v[20:23]
    ds_read_b128 v[76:79], v235 offset:14784
    s_waitcnt lgkmcnt(8)
    v_mfma_f32_16x16x32_bf16 v[24:27], v[104:107], v[168:171], v[24:27]
    ds_read_b128 v[80:83], v235 offset:208
    v_mfma_f32_16x16x32_bf16 v[28:31], v[108:111], v[168:171], v[28:31]
    ds_read_b128 v[84:87], v235 offset:5072
    s_waitcnt lgkmcnt(8)
    v_mfma_f32_16x16x32_bf16 v[16:19], v[112:115], v[172:175], v[16:19]
    ds_read_b128 v[88:91], v235 offset:9936
    v_mfma_f32_16x16x32_bf16 v[20:23], v[116:119], v[172:175], v[20:23]
    ds_read_b128 v[92:95], v235 offset:14800
    s_waitcnt lgkmcnt(8)
    v_mfma_f32_16x16x32_bf16 v[24:27], v[120:123], v[172:175], v[24:27]
    ds_read_b128 v[96:99], v235 offset:224
    v_mfma_f32_16x16x32_bf16 v[28:31], v[124:127], v[172:175], v[28:31]
    ds_read_b128 v[100:103], v235 offset:5088
    s_waitcnt lgkmcnt(8)
    v_mfma_f32_16x16x32_bf16 v[16:19], v[64:67], v[176:179], v[16:19]
    ds_read_b128 v[104:107], v235 offset:9952
    v_mfma_f32_16x16x32_bf16 v[20:23], v[68:71], v[176:179], v[20:23]
    ds_read_b128 v[108:111], v235 offset:14816
    s_waitcnt lgkmcnt(8)
    v_mfma_f32_16x16x32_bf16 v[24:27], v[72:75], v[176:179], v[24:27]
    ds_read_b128 v[112:115], v235 offset:240
    v_mfma_f32_16x16x32_bf16 v[28:31], v[76:79], v[176:179], v[28:31]
    ds_read_b128 v[116:119], v235 offset:5104
    s_waitcnt lgkmcnt(8)
    v_mfma_f32_16x16x32_bf16 v[16:19], v[80:83], v[180:183], v[16:19]
    ds_read_b128 v[120:123], v235 offset:9968
    v_mfma_f32_16x16x32_bf16 v[20:23], v[84:87], v[180:183], v[20:23]
    ds_read_b128 v[124:127], v235 offset:14832
    s_waitcnt lgkmcnt(8)
    v_mfma_f32_16x16x32_bf16 v[24:27], v[88:91], v[180:183], v[24:27]
    ds_read_b128 v[64:67], v235 offset:256
    v_mfma_f32_16x16x32_bf16 v[28:31], v[92:95], v[180:183], v[28:31]
    ds_read_b128 v[68:71], v235 offset:5120
    s_waitcnt lgkmcnt(8)
    v_mfma_f32_16x16x32_bf16 v[16:19], v[96:99], v[184:187], v[16:19]
    ds_read_b128 v[72:75], v235 offset:9984
    v_mfma_f32_16x16x32_bf16 v[20:23], v[100:103], v[184:187], v[20:23]
    ds_read_b128 v[76:79], v235 offset:14848
    s_waitcnt lgkmcnt(8)
    v_mfma_f32_16x16x32_bf16 v[24:27], v[104:107], v[184:187], v[24:27]
    ds_read_b128 v[80:83], v235 offset:272
    v_mfma_f32_16x16x32_bf16 v[28:31], v[108:111], v[184:187], v[28:31]
    ds_read_b128 v[84:87], v235 offset:5136
    s_waitcnt lgkmcnt(8)
    v_mfma_f32_16x16x32_bf16 v[16:19], v[112:115], v[188:191], v[16:19]
    ds_read_b128 v[88:91], v235 offset:10000
    v_mfma_f32_16x16x32_bf16 v[20:23], v[116:119], v[188:191], v[20:23]
    ds_read_b128 v[92:95], v235 offset:14864
    s_waitcnt lgkmcnt(8)
    v_mfma_f32_16x16x32_bf16 v[24:27], v[120:123], v[188:191], v[24:27]
    v_mfma_f32_16x16x32_bf16 v[28:31], v[124:127], v[188:191], v[28:31]
    s_waitcnt lgkmcnt(6)
    v_mfma_f32_16x16x32_bf16 v[16:19], v[64:67], v[192:195], v[16:19]
    v_mfma_f32_16x16x32_bf16 v[20:23], v[68:71], v[192:195], v[20:23]
    s_waitcnt lgkmcnt(4)
    v_mfma_f32_16x16x32_bf16 v[24:27], v[72:75], v[192:195], v[24:27]
    v_mfma_f32_16x16x32_bf16 v[28:31], v[76:79], v[192:195], v[28:31]
    s_waitcnt lgkmcnt(2)
    v_mfma_f32_16x16x32_bf16 v[16:19], v[80:83], v[196:199], v[16:19]
    v_mfma_f32_16x16x32_bf16 v[20:23], v[84:87], v[196:199], v[20:23]
    s_waitcnt lgkmcnt(0)
    v_mfma_f32_16x16x32_bf16 v[24:27], v[88:91], v[196:199], v[24:27]
    v_mfma_f32_16x16x32_bf16 v[28:31], v[92:95], v[196:199], v[28:31]
    s_nop 5
    v_cvt_pk_bf16_f32 v64, v16, v17
    v_cvt_pk_bf16_f32 v65, v18, v19
    v_cvt_pk_bf16_f32 v66, v20, v21
    v_cvt_pk_bf16_f32 v67, v22, v23
    s_nop 1
    v_permlane32_swap_b32 v64, v66
    v_permlane32_swap_b32 v65, v67
    s_nop 1
    v_permlane16_swap_b32 v64, v66
    v_permlane16_swap_b32 v65, v67
    s_nop 1
    buffer_store_dwordx4 v[64:67], v12, s[16:19], s25 offen offset:0
    v_cvt_pk_bf16_f32 v68, v24, v25
    v_cvt_pk_bf16_f32 v69, v26, v27
    v_cvt_pk_bf16_f32 v70, v28, v29
    v_cvt_pk_bf16_f32 v71, v30, v31
    s_nop 1
    v_permlane32_swap_b32 v68, v70
    v_permlane32_swap_b32 v69, v71
    s_nop 1
    v_permlane16_swap_b32 v68, v70
    v_permlane16_swap_b32 v69, v71
    s_nop 1
    buffer_store_dwordx4 v[68:71], v12, s[16:19], s25 offen offset:64
    s_endpgm
L_roleB:
    s_cmp_eq_u32 s2, 248
    s_cbranch_scc1 L_roleZ
    s_sub_u32 s20, s2, 176
    v_subrev_u32 v5, 0, v0
    s_mul_i32 s21, s20, 472
    v_add_u32 v4, s21, v5
    s_movk_i32 s22, 472
    v_cmp_gt_u32 s[26:27], s22, v5
    s_mov_b32 s22, 15552
    v_cmp_gt_u32 vcc, s22, v4
    v_lshlrev_b32 v2, 7, v4
    s_and_b64 exec, vcc, s[26:27]
    s_cbranch_execz L_dpf_4
    global_load_dword v253, v2, s[42:43]
L_dpf_4:
    s_mov_b64 exec, -1
    v_subrev_u32 v4, 15552, v4
    s_mov_b32 s22, 18432
    v_cmp_gt_u32 vcc, s22, v4
    v_lshlrev_b32 v2, 7, v4
    s_and_b64 exec, vcc, s[26:27]
    s_cbranch_execz L_dpf_5
    global_load_dword v254, v2, s[40:41]
L_dpf_5:
    s_mov_b64 exec, -1
    v_subrev_u32 v4, 18432, v4
    s_and_b32 s21, s20, 7
    s_mul_i32 s21, s21, 9
    s_lshr_b32 s22, s20, 3
    s_add_u32 s21, s21, s22
    s_lshl_b32 s22, s21, 3
    s_add_u32 s22, s22, s3
    s_mul_i32 s23, s3, 13056
    s_lshl_b32 s24, s22, 12
    s_lshr_b32 s25, s22, 1
    s_lshl_b32 s25, s25, 2
    s_load_dword s64, s[56:57], s25
    s_cmp_ge_u32 s3, 4
    s_cbranch_scc1 L_B_other
    s_mov_b32 s16, s48
    s_and_b32 s17, s49, 0xffff
    s_mov_b32 s18, 2359296
    s_mov_b32 s19, 0x20000
    s_mov_b32 s24, s50
    s_and_b32 s25, s51, 0xffff
    s_mov_b32 s26, 2359296
    s_mov_b32 s27, 0x20000
    s_lshr_b32 s23, s20, 3
    s_and_b32 s22, s20, 7
    s_lshl_b32 s22, s22, 8
    s_lshl_b32 s21, s3, 6
    s_add_u32 s22, s22, s21
    v_and_b32 v2, 7, v1
    v_lshrrev_b32 v3, 3, v1
    v_lshl_add_u32 v4, v3, 3, s22
    v_mul_u32_u24 v5, 1152, v4
    s_lshl_b32 s37, s23, 7
    v_lshl_add_u32 v6, v2, 4, s37
    v_add_u32 v5, v5, v6
    v_subrev_u32 v7, 3456, v5
    v_cmp_eq_u32 vcc, 0, v4
    v_mov_b32 v8, 0x40000000
    s_movk_i32 s38, 4608
    v_cndmask_b32 v7, v7, v8, vcc
    buffer_load_dwordx4 v[16:19], v7, s[16:19], 0 offen offset:0 nt
    buffer_load_dwordx4 v[20:23], v7, s[16:19], 0 offen offset:1152 nt
    buffer_load_dwordx4 v[24:27], v7, s[16:19], 0 offen offset:2304 nt
    buffer_load_dwordx4 v[28:31], v5, s[16:19], 0 offen offset:0 nt
    buffer_load_dwordx4 v[32:35], v5, s[16:19], 0 offen offset:1152 nt
    buffer_load_dwordx4 v[36:39], v5, s[16:19], 0 offen offset:2304 nt
    buffer_load_dwordx4 v[40:43], v5, s[16:19], 0 offen offset:3456 nt
    buffer_load_dwordx4 v[44:47], v5, s[16:19], s38 offen offset:0 nt
    buffer_load_dwordx4 v[48:51], v5, s[16:19], s38 offen offset:1152 nt
    buffer_load_dwordx4 v[52:55], v5, s[16:19], s38 offen offset:2304 nt
    buffer_load_dwordx4 v[56:59], v5, s[16:19], s38 offen offset:3456 nt
    s_mov_b32 s32, s52
    s_and_b32 s33, s53, 0xffff
    s_mov_b32 s34, 4608
    s_mov_b32 s35, 0x20000
    v_lshlrev_b32 v9, 2, v6
    buffer_load_dwordx4 v[124:127], v9, s[32:35], 0 offen offset:0
    buffer_load_dwordx4 v[128:131], v9, s[32:35], 0 offen offset:16
    buffer_load_dwordx4 v[132:135], v9, s[32:35], 0 offen offset:32
    buffer_load_dwordx4 v[136:139], v9, s[32:35], 0 offen offset:48
    buffer_load_dwordx4 v[60:63], v5, s[24:27], 0 offen offset:0 nt
    buffer_load_dwordx4 v[64:67], v5, s[24:27], 0 offen offset:1152 nt
    buffer_load_dwordx4 v[68:71], v5, s[24:27], 0 offen offset:2304 nt
    buffer_load_dwordx4 v[72:75], v5, s[24:27], 0 offen offset:3456 nt
    buffer_load_dwordx4 v[76:79], v5, s[24:27], s38 offen offset:0 nt
    buffer_load_dwordx4 v[80:83], v5, s[24:27], s38 offen offset:1152 nt
    buffer_load_dwordx4 v[84:87], v5, s[24:27], s38 offen offset:2304 nt
    buffer_load_dwordx4 v[88:91], v5, s[24:27], s38 offen offset:3456 nt
    s_mov_b32 s12, s62
    s_and_b32 s13, s63, 0xffff
    s_mov_b32 s14, 8388608
    s_mov_b32 s15, 0x20000
    v_lshlrev_b32 v10, 11, v6
    v_lshlrev_b32 v11, 1, v4
    v_sub_u32 v13, v10, v11
    v_add_u32 v13, 4080, v13
    v_mov_b32 v14, 0xffff0000
    s_waitcnt vmcnt(0)
    v_lshlrev_b32 v164, 16, v124
    v_lshlrev_b32 v165, 16, v126
    v_and_b32 v166, v14, v124
    v_and_b32 v167, v14, v126
    v_lshlrev_b32 v168, 16, v125
    v_lshlrev_b32 v169, 16, v127
    v_and_b32 v170, v14, v125
    v_and_b32 v171, v14, v127
    v_lshlrev_b32 v140, 16, v16
    v_and_b32 v141, v14, v16
    v_lshlrev_b32 v142, 16, v20
    v_and_b32 v143, v14, v20
    v_lshlrev_b32 v144, 16, v24
    v_and_b32 v145, v14, v24
    v_lshlrev_b32 v146, 16, v28
    v_and_b32 v147, v14, v28
    v_lshlrev_b32 v148, 16, v32
    v_and_b32 v149, v14, v32
    v_lshlrev_b32 v150, 16, v36
    v_and_b32 v151, v14, v36
    v_lshlrev_b32 v152, 16, v40
    v_and_b32 v153, v14, v40
    v_lshlrev_b32 v154, 16, v44
    v_and_b32 v155, v14, v44
    v_lshlrev_b32 v156, 16, v48
    v_and_b32 v157, v14, v48
    v_lshlrev_b32 v158, 16, v52
    v_and_b32 v159, v14, v52
    v_lshlrev_b32 v160, 16, v56
    v_and_b32 v161, v14, v56
    v_pk_mul_f32 v[172:173], v[140:141], v[170:171]
    v_pk_mul_f32 v[174:175], v[142:143], v[170:171]
    v_pk_mul_f32 v[176:177], v[144:145], v[170:171]
    v_pk_mul_f32 v[178:179], v[146:147], v[170:171]
    v_pk_mul_f32 v[180:181], v[148:149], v[170:171]
    v_pk_mul_f32 v[182:183], v[150:151], v[170:171]
    v_pk_mul_f32 v[184:185], v[152:153], v[170:171]
    v_pk_mul_f32 v[186:187], v[154:155], v[170:171]
    v_pk_fma_f32 v[172:173], v[142:143], v[168:169], v[172:173]
    v_pk_fma_f32 v[174:175], v[144:145], v[168:169], v[174:175]
    v_pk_fma_f32 v[176:177], v[146:147], v[168:169], v[176:177]
    v_pk_fma_f32 v[178:179], v[148:149], v[168:169], v[178:179]
    v_pk_fma_f32 v[180:181], v[150:151], v[168:169], v[180:181]
    v_pk_fma_f32 v[182:183], v[152:153], v[168:169], v[182:183]
    v_pk_fma_f32 v[184:185], v[154:155], v[168:169], v[184:185]
    v_pk_fma_f32 v[186:187], v[156:157], v[168:169], v[186:187]
    v_pk_fma_f32 v[172:173], v[144:145], v[166:167], v[172:173]
    v_pk_fma_f32 v[174:175], v[146:147], v[166:167], v[174:175]
    v_pk_fma_f32 v[176:177], v[148:149], v[166:167], v[176:177]
    v_pk_fma_f32 v[178:179], v[150:151], v[166:167], v[178:179]
    v_pk_fma_f32 v[180:181], v[152:153], v[166:167], v[180:181]
    v_pk_fma_f32 v[182:183], v[154:155], v[166:167], v[182:183]
    v_pk_fma_f32 v[184:185], v[156:157], v[166:167], v[184:185]
    v_pk_fma_f32 v[186:187], v[158:159], v[166:167], v[186:187]
    v_pk_fma_f32 v[172:173], v[146:147], v[164:165], v[172:173]
    v_pk_fma_f32 v[174:175], v[148:149], v[164:165], v[174:175]
    v_pk_fma_f32 v[176:177], v[150:151], v[164:165], v[176:177]
    v_pk_fma_f32 v[178:179], v[152:153], v[164:165], v[178:179]
    v_pk_fma_f32 v[180:181], v[154:155], v[164:165], v[180:181]
    v_pk_fma_f32 v[182:183], v[156:157], v[164:165], v[182:183]
    v_pk_fma_f32 v[184:185], v[158:159], v[164:165], v[184:185]
    v_pk_fma_f32 v[186:187], v[160:161], v[164:165], v[186:187]
    v_lshlrev_b32 v140, 16, v60
    v_and_b32 v141, v14, v60
    v_lshlrev_b32 v142, 16, v64
    v_and_b32 v143, v14, v64
    v_lshlrev_b32 v144, 16, v68
    v_and_b32 v145, v14, v68
    v_lshlrev_b32 v146, 16, v72
    v_and_b32 v147, v14, v72
    v_lshlrev_b32 v148, 16, v76
    v_and_b32 v149, v14, v76
    v_lshlrev_b32 v150, 16, v80
    v_and_b32 v151, v14, v80
    v_lshlrev_b32 v152, 16, v84
    v_and_b32 v153, v14, v84
    v_lshlrev_b32 v154, 16, v88
    v_and_b32 v155, v14, v88
    v_pk_mul_f32 v[172:173], v[172:173], v[140:141]
    v_pk_mul_f32 v[174:175], v[174:175], v[142:143]
    v_pk_mul_f32 v[176:177], v[176:177], v[144:145]
    v_pk_mul_f32 v[178:179], v[178:179], v[146:147]
    v_pk_mul_f32 v[180:181], v[180:181], v[148:149]
    v_pk_mul_f32 v[182:183], v[182:183], v[150:151]
    v_pk_mul_f32 v[184:185], v[184:185], v[152:153]
    v_pk_mul_f32 v[186:187], v[186:187], v[154:155]
    v_cvt_pk_bf16_f32 v92, v186, v184
    v_cvt_pk_bf16_f32 v93, v182, v180
    v_cvt_pk_bf16_f32 v94, v178, v176
    v_cvt_pk_bf16_f32 v95, v174, v172
    s_mov_b32 s39, 0
    buffer_store_dwordx4 v[92:95], v13, s[12:15], s39 offen sc1
    v_cvt_pk_bf16_f32 v96, v187, v185
    v_cvt_pk_bf16_f32 v97, v183, v181
    v_cvt_pk_bf16_f32 v98, v179, v177
    v_cvt_pk_bf16_f32 v99, v175, v173
    s_mov_b32 s39, 4096
    buffer_store_dwordx4 v[96:99], v13, s[12:15], s39 offen sc1
    v_lshlrev_b32 v164, 16, v128
    v_lshlrev_b32 v165, 16, v130
    v_and_b32 v166, v14, v128
    v_and_b32 v167, v14, v130
    v_lshlrev_b32 v168, 16, v129
    v_lshlrev_b32 v169, 16, v131
    v_and_b32 v170, v14, v129
    v_and_b32 v171, v14, v131
    v_lshlrev_b32 v140, 16, v17
    v_and_b32 v141, v14, v17
    v_lshlrev_b32 v142, 16, v21
    v_and_b32 v143, v14, v21
    v_lshlrev_b32 v144, 16, v25
    v_and_b32 v145, v14, v25
    v_lshlrev_b32 v146, 16, v29
    v_and_b32 v147, v14, v29
    v_lshlrev_b32 v148, 16, v33
    v_and_b32 v149, v14, v33
    v_lshlrev_b32 v150, 16, v37
    v_and_b32 v151, v14, v37
    v_lshlrev_b32 v152, 16, v41
    v_and_b32 v153, v14, v41
    v_lshlrev_b32 v154, 16, v45
    v_and_b32 v155, v14, v45
    v_lshlrev_b32 v156, 16, v49
    v_and_b32 v157, v14, v49
    v_lshlrev_b32 v158, 16, v53
    v_and_b32 v159, v14, v53
    v_lshlrev_b32 v160, 16, v57
    v_and_b32 v161, v14, v57
    v_pk_mul_f32 v[172:173], v[140:141], v[170:171]
    v_pk_mul_f32 v[174:175], v[142:143], v[170:171]
    v_pk_mul_f32 v[176:177], v[144:145], v[170:171]
    v_pk_mul_f32 v[178:179], v[146:147], v[170:171]
    v_pk_mul_f32 v[180:181], v[148:149], v[170:171]
    v_pk_mul_f32 v[182:183], v[150:151], v[170:171]
    v_pk_mul_f32 v[184:185], v[152:153], v[170:171]
    v_pk_mul_f32 v[186:187], v[154:155], v[170:171]
    v_pk_fma_f32 v[172:173], v[142:143], v[168:169], v[172:173]
    v_pk_fma_f32 v[174:175], v[144:145], v[168:169], v[174:175]
    v_pk_fma_f32 v[176:177], v[146:147], v[168:169], v[176:177]
    v_pk_fma_f32 v[178:179], v[148:149], v[168:169], v[178:179]
    v_pk_fma_f32 v[180:181], v[150:151], v[168:169], v[180:181]
    v_pk_fma_f32 v[182:183], v[152:153], v[168:169], v[182:183]
    v_pk_fma_f32 v[184:185], v[154:155], v[168:169], v[184:185]
    v_pk_fma_f32 v[186:187], v[156:157], v[168:169], v[186:187]
    v_pk_fma_f32 v[172:173], v[144:145], v[166:167], v[172:173]
    v_pk_fma_f32 v[174:175], v[146:147], v[166:167], v[174:175]
    v_pk_fma_f32 v[176:177], v[148:149], v[166:167], v[176:177]
    v_pk_fma_f32 v[178:179], v[150:151], v[166:167], v[178:179]
    v_pk_fma_f32 v[180:181], v[152:153], v[166:167], v[180:181]
    v_pk_fma_f32 v[182:183], v[154:155], v[166:167], v[182:183]
    v_pk_fma_f32 v[184:185], v[156:157], v[166:167], v[184:185]
    v_pk_fma_f32 v[186:187], v[158:159], v[166:167], v[186:187]
    v_pk_fma_f32 v[172:173], v[146:147], v[164:165], v[172:173]
    v_pk_fma_f32 v[174:175], v[148:149], v[164:165], v[174:175]
    v_pk_fma_f32 v[176:177], v[150:151], v[164:165], v[176:177]
    v_pk_fma_f32 v[178:179], v[152:153], v[164:165], v[178:179]
    v_pk_fma_f32 v[180:181], v[154:155], v[164:165], v[180:181]
    v_pk_fma_f32 v[182:183], v[156:157], v[164:165], v[182:183]
    v_pk_fma_f32 v[184:185], v[158:159], v[164:165], v[184:185]
    v_pk_fma_f32 v[186:187], v[160:161], v[164:165], v[186:187]
    v_lshlrev_b32 v140, 16, v61
    v_and_b32 v141, v14, v61
    v_lshlrev_b32 v142, 16, v65
    v_and_b32 v143, v14, v65
    v_lshlrev_b32 v144, 16, v69
    v_and_b32 v145, v14, v69
    v_lshlrev_b32 v146, 16, v73
    v_and_b32 v147, v14, v73
    v_lshlrev_b32 v148, 16, v77
    v_and_b32 v149, v14, v77
    v_lshlrev_b32 v150, 16, v81
    v_and_b32 v151, v14, v81
    v_lshlrev_b32 v152, 16, v85
    v_and_b32 v153, v14, v85
    v_lshlrev_b32 v154, 16, v89
    v_and_b32 v155, v14, v89
    v_pk_mul_f32 v[172:173], v[172:173], v[140:141]
    v_pk_mul_f32 v[174:175], v[174:175], v[142:143]
    v_pk_mul_f32 v[176:177], v[176:177], v[144:145]
    v_pk_mul_f32 v[178:179], v[178:179], v[146:147]
    v_pk_mul_f32 v[180:181], v[180:181], v[148:149]
    v_pk_mul_f32 v[182:183], v[182:183], v[150:151]
    v_pk_mul_f32 v[184:185], v[184:185], v[152:153]
    v_pk_mul_f32 v[186:187], v[186:187], v[154:155]
    v_cvt_pk_bf16_f32 v100, v186, v184
    v_cvt_pk_bf16_f32 v101, v182, v180
    v_cvt_pk_bf16_f32 v102, v178, v176
    v_cvt_pk_bf16_f32 v103, v174, v172
    s_mov_b32 s39, 8192
    buffer_store_dwordx4 v[100:103], v13, s[12:15], s39 offen sc1
    v_cvt_pk_bf16_f32 v104, v187, v185
    v_cvt_pk_bf16_f32 v105, v183, v181
    v_cvt_pk_bf16_f32 v106, v179, v177
    v_cvt_pk_bf16_f32 v107, v175, v173
    s_mov_b32 s39, 12288
    buffer_store_dwordx4 v[104:107], v13, s[12:15], s39 offen sc1
    v_lshlrev_b32 v164, 16, v132
    v_lshlrev_b32 v165, 16, v134
    v_and_b32 v166, v14, v132
    v_and_b32 v167, v14, v134
    v_lshlrev_b32 v168, 16, v133
    v_lshlrev_b32 v169, 16, v135
    v_and_b32 v170, v14, v133
    v_and_b32 v171, v14, v135
    v_lshlrev_b32 v140, 16, v18
    v_and_b32 v141, v14, v18
    v_lshlrev_b32 v142, 16, v22
    v_and_b32 v143, v14, v22
    v_lshlrev_b32 v144, 16, v26
    v_and_b32 v145, v14, v26
    v_lshlrev_b32 v146, 16, v30
    v_and_b32 v147, v14, v30
    v_lshlrev_b32 v148, 16, v34
    v_and_b32 v149, v14, v34
    v_lshlrev_b32 v150, 16, v38
    v_and_b32 v151, v14, v38
    v_lshlrev_b32 v152, 16, v42
    v_and_b32 v153, v14, v42
    v_lshlrev_b32 v154, 16, v46
    v_and_b32 v155, v14, v46
    v_lshlrev_b32 v156, 16, v50
    v_and_b32 v157, v14, v50
    v_lshlrev_b32 v158, 16, v54
    v_and_b32 v159, v14, v54
    v_lshlrev_b32 v160, 16, v58
    v_and_b32 v161, v14, v58
    v_pk_mul_f32 v[172:173], v[140:141], v[170:171]
    v_pk_mul_f32 v[174:175], v[142:143], v[170:171]
    v_pk_mul_f32 v[176:177], v[144:145], v[170:171]
    v_pk_mul_f32 v[178:179], v[146:147], v[170:171]
    v_pk_mul_f32 v[180:181], v[148:149], v[170:171]
    v_pk_mul_f32 v[182:183], v[150:151], v[170:171]
    v_pk_mul_f32 v[184:185], v[152:153], v[170:171]
    v_pk_mul_f32 v[186:187], v[154:155], v[170:171]
    v_pk_fma_f32 v[172:173], v[142:143], v[168:169], v[172:173]
    v_pk_fma_f32 v[174:175], v[144:145], v[168:169], v[174:175]
    v_pk_fma_f32 v[176:177], v[146:147], v[168:169], v[176:177]
    v_pk_fma_f32 v[178:179], v[148:149], v[168:169], v[178:179]
    v_pk_fma_f32 v[180:181], v[150:151], v[168:169], v[180:181]
    v_pk_fma_f32 v[182:183], v[152:153], v[168:169], v[182:183]
    v_pk_fma_f32 v[184:185], v[154:155], v[168:169], v[184:185]
    v_pk_fma_f32 v[186:187], v[156:157], v[168:169], v[186:187]
    v_pk_fma_f32 v[172:173], v[144:145], v[166:167], v[172:173]
    v_pk_fma_f32 v[174:175], v[146:147], v[166:167], v[174:175]
    v_pk_fma_f32 v[176:177], v[148:149], v[166:167], v[176:177]
    v_pk_fma_f32 v[178:179], v[150:151], v[166:167], v[178:179]
    v_pk_fma_f32 v[180:181], v[152:153], v[166:167], v[180:181]
    v_pk_fma_f32 v[182:183], v[154:155], v[166:167], v[182:183]
    v_pk_fma_f32 v[184:185], v[156:157], v[166:167], v[184:185]
    v_pk_fma_f32 v[186:187], v[158:159], v[166:167], v[186:187]
    v_pk_fma_f32 v[172:173], v[146:147], v[164:165], v[172:173]
    v_pk_fma_f32 v[174:175], v[148:149], v[164:165], v[174:175]
    v_pk_fma_f32 v[176:177], v[150:151], v[164:165], v[176:177]
    v_pk_fma_f32 v[178:179], v[152:153], v[164:165], v[178:179]
    v_pk_fma_f32 v[180:181], v[154:155], v[164:165], v[180:181]
    v_pk_fma_f32 v[182:183], v[156:157], v[164:165], v[182:183]
    v_pk_fma_f32 v[184:185], v[158:159], v[164:165], v[184:185]
    v_pk_fma_f32 v[186:187], v[160:161], v[164:165], v[186:187]
    v_lshlrev_b32 v140, 16, v62
    v_and_b32 v141, v14, v62
    v_lshlrev_b32 v142, 16, v66
    v_and_b32 v143, v14, v66
    v_lshlrev_b32 v144, 16, v70
    v_and_b32 v145, v14, v70
    v_lshlrev_b32 v146, 16, v74
    v_and_b32 v147, v14, v74
    v_lshlrev_b32 v148, 16, v78
    v_and_b32 v149, v14, v78
    v_lshlrev_b32 v150, 16, v82
    v_and_b32 v151, v14, v82
    v_lshlrev_b32 v152, 16, v86
    v_and_b32 v153, v14, v86
    v_lshlrev_b32 v154, 16, v90
    v_and_b32 v155, v14, v90
    v_pk_mul_f32 v[172:173], v[172:173], v[140:141]
    v_pk_mul_f32 v[174:175], v[174:175], v[142:143]
    v_pk_mul_f32 v[176:177], v[176:177], v[144:145]
    v_pk_mul_f32 v[178:179], v[178:179], v[146:147]
    v_pk_mul_f32 v[180:181], v[180:181], v[148:149]
    v_pk_mul_f32 v[182:183], v[182:183], v[150:151]
    v_pk_mul_f32 v[184:185], v[184:185], v[152:153]
    v_pk_mul_f32 v[186:187], v[186:187], v[154:155]
    v_cvt_pk_bf16_f32 v108, v186, v184
    v_cvt_pk_bf16_f32 v109, v182, v180
    v_cvt_pk_bf16_f32 v110, v178, v176
    v_cvt_pk_bf16_f32 v111, v174, v172
    s_mov_b32 s39, 16384
    buffer_store_dwordx4 v[108:111], v13, s[12:15], s39 offen sc1
    v_cvt_pk_bf16_f32 v112, v187, v185
    v_cvt_pk_bf16_f32 v113, v183, v181
    v_cvt_pk_bf16_f32 v114, v179, v177
    v_cvt_pk_bf16_f32 v115, v175, v173
    s_mov_b32 s39, 20480
    buffer_store_dwordx4 v[112:115], v13, s[12:15], s39 offen sc1
    v_lshlrev_b32 v164, 16, v136
    v_lshlrev_b32 v165, 16, v138
    v_and_b32 v166, v14, v136
    v_and_b32 v167, v14, v138
    v_lshlrev_b32 v168, 16, v137
    v_lshlrev_b32 v169, 16, v139
    v_and_b32 v170, v14, v137
    v_and_b32 v171, v14, v139
    v_lshlrev_b32 v140, 16, v19
    v_and_b32 v141, v14, v19
    v_lshlrev_b32 v142, 16, v23
    v_and_b32 v143, v14, v23
    v_lshlrev_b32 v144, 16, v27
    v_and_b32 v145, v14, v27
    v_lshlrev_b32 v146, 16, v31
    v_and_b32 v147, v14, v31
    v_lshlrev_b32 v148, 16, v35
    v_and_b32 v149, v14, v35
    v_lshlrev_b32 v150, 16, v39
    v_and_b32 v151, v14, v39
    v_lshlrev_b32 v152, 16, v43
    v_and_b32 v153, v14, v43
    v_lshlrev_b32 v154, 16, v47
    v_and_b32 v155, v14, v47
    v_lshlrev_b32 v156, 16, v51
    v_and_b32 v157, v14, v51
    v_lshlrev_b32 v158, 16, v55
    v_and_b32 v159, v14, v55
    v_lshlrev_b32 v160, 16, v59
    v_and_b32 v161, v14, v59
    v_pk_mul_f32 v[172:173], v[140:141], v[170:171]
    v_pk_mul_f32 v[174:175], v[142:143], v[170:171]
    v_pk_mul_f32 v[176:177], v[144:145], v[170:171]
    v_pk_mul_f32 v[178:179], v[146:147], v[170:171]
    v_pk_mul_f32 v[180:181], v[148:149], v[170:171]
    v_pk_mul_f32 v[182:183], v[150:151], v[170:171]
    v_pk_mul_f32 v[184:185], v[152:153], v[170:171]
    v_pk_mul_f32 v[186:187], v[154:155], v[170:171]
    v_pk_fma_f32 v[172:173], v[142:143], v[168:169], v[172:173]
    v_pk_fma_f32 v[174:175], v[144:145], v[168:169], v[174:175]
    v_pk_fma_f32 v[176:177], v[146:147], v[168:169], v[176:177]
    v_pk_fma_f32 v[178:179], v[148:149], v[168:169], v[178:179]
    v_pk_fma_f32 v[180:181], v[150:151], v[168:169], v[180:181]
    v_pk_fma_f32 v[182:183], v[152:153], v[168:169], v[182:183]
    v_pk_fma_f32 v[184:185], v[154:155], v[168:169], v[184:185]
    v_pk_fma_f32 v[186:187], v[156:157], v[168:169], v[186:187]
    v_pk_fma_f32 v[172:173], v[144:145], v[166:167], v[172:173]
    v_pk_fma_f32 v[174:175], v[146:147], v[166:167], v[174:175]
    v_pk_fma_f32 v[176:177], v[148:149], v[166:167], v[176:177]
    v_pk_fma_f32 v[178:179], v[150:151], v[166:167], v[178:179]
    v_pk_fma_f32 v[180:181], v[152:153], v[166:167], v[180:181]
    v_pk_fma_f32 v[182:183], v[154:155], v[166:167], v[182:183]
    v_pk_fma_f32 v[184:185], v[156:157], v[166:167], v[184:185]
    v_pk_fma_f32 v[186:187], v[158:159], v[166:167], v[186:187]
    v_pk_fma_f32 v[172:173], v[146:147], v[164:165], v[172:173]
    v_pk_fma_f32 v[174:175], v[148:149], v[164:165], v[174:175]
    v_pk_fma_f32 v[176:177], v[150:151], v[164:165], v[176:177]
    v_pk_fma_f32 v[178:179], v[152:153], v[164:165], v[178:179]
    v_pk_fma_f32 v[180:181], v[154:155], v[164:165], v[180:181]
    v_pk_fma_f32 v[182:183], v[156:157], v[164:165], v[182:183]
    v_pk_fma_f32 v[184:185], v[158:159], v[164:165], v[184:185]
    v_pk_fma_f32 v[186:187], v[160:161], v[164:165], v[186:187]
    v_lshlrev_b32 v140, 16, v63
    v_and_b32 v141, v14, v63
    v_lshlrev_b32 v142, 16, v67
    v_and_b32 v143, v14, v67
    v_lshlrev_b32 v144, 16, v71
    v_and_b32 v145, v14, v71
    v_lshlrev_b32 v146, 16, v75
    v_and_b32 v147, v14, v75
    v_lshlrev_b32 v148, 16, v79
    v_and_b32 v149, v14, v79
    v_lshlrev_b32 v150, 16, v83
    v_and_b32 v151, v14, v83
    v_lshlrev_b32 v152, 16, v87
    v_and_b32 v153, v14, v87
    v_lshlrev_b32 v154, 16, v91
    v_and_b32 v155, v14, v91
    v_pk_mul_f32 v[172:173], v[172:173], v[140:141]
    v_pk_mul_f32 v[174:175], v[174:175], v[142:143]
    v_pk_mul_f32 v[176:177], v[176:177], v[144:145]
    v_pk_mul_f32 v[178:179], v[178:179], v[146:147]
    v_pk_mul_f32 v[180:181], v[180:181], v[148:149]
    v_pk_mul_f32 v[182:183], v[182:183], v[150:151]
    v_pk_mul_f32 v[184:185], v[184:185], v[152:153]
    v_pk_mul_f32 v[186:187], v[186:187], v[154:155]
    v_cvt_pk_bf16_f32 v116, v186, v184
    v_cvt_pk_bf16_f32 v117, v182, v180
    v_cvt_pk_bf16_f32 v118, v178, v176
    v_cvt_pk_bf16_f32 v119, v174, v172
    s_mov_b32 s39, 24576
    buffer_store_dwordx4 v[116:119], v13, s[12:15], s39 offen sc1
    v_cvt_pk_bf16_f32 v120, v187, v185
    v_cvt_pk_bf16_f32 v121, v183, v181
    v_cvt_pk_bf16_f32 v122, v179, v177
    v_cvt_pk_bf16_f32 v123, v175, v173
    s_mov_b32 s39, 28672
    buffer_store_dwordx4 v[120:123], v13, s[12:15], s39 offen sc1
    s_waitcnt vmcnt(0)
    s_branch L_B_noprep
L_B_other:
    s_waitcnt vmcnt(0)
    s_mul_i32 s21, s20, 72
    v_subrev_u32 v4, 256, v0
    s_movk_i32 s22, 72
    v_cmp_gt_u32 vcc, s22, v4
    v_add_u32 v2, s21, v4
    v_lshlrev_b32 v2, 7, v2
    s_and_saveexec_b64 s[22:23], vcc
    s_cbranch_execz L_B_nowo
    global_load_dword v255, v2, s[44:45]
L_B_nowo:
    s_mov_b64 exec, -1
    s_and_b32 s21, s20, 7
    s_mul_i32 s21, s21, 9
    s_lshr_b32 s22, s20, 3
    s_add_u32 s21, s21, s22
    s_lshl_b32 s22, s21, 3
    s_add_u32 s22, s22, s3
    s_mul_i32 s23, s3, 13056
    s_lshl_b32 s24, s22, 12
    s_mov_b32 s16, s54
    s_and_b32 s17, s55, 0xffff
    s_mov_b32 s18, 2359296
    s_mov_b32 s19, 0x20000
    s_sub_u32 s26, s24, 16384
    v_lshlrev_b32 v2, 4, v1
    buffer_load_dwordx4 v[128:131], v2, s[16:19], s26 offen offset:0 nt
    buffer_load_dword v132, v2, s[16:19], s26 offen offset:16 nt
    buffer_load_dwordx4 v[136:139], v2, s[16:19], s26 offen offset:1024 nt
    buffer_load_dword v140, v2, s[16:19], s26 offen offset:1040 nt
    buffer_load_dwordx4 v[144:147], v2, s[16:19], s26 offen offset:2048 nt
    buffer_load_dword v148, v2, s[16:19], s26 offen offset:2064 nt
    buffer_load_dwordx4 v[152:155], v2, s[16:19], s26 offen offset:3072 nt
    buffer_load_dword v156, v2, s[16:19], s26 offen offset:3088 nt
    v_lshlrev_b32 v2, 4, v1
    buffer_load_dwordx4 v[160:163], v2, s[16:19], s24 offen offset:0 nt
    buffer_load_dword v164, v2, s[16:19], s24 offen offset:16 nt
    buffer_load_dwordx4 v[168:171], v2, s[16:19], s24 offen offset:1024 nt
    buffer_load_dword v172, v2, s[16:19], s24 offen offset:1040 nt
    buffer_load_dwordx4 v[176:179], v2, s[16:19], s24 offen offset:2048 nt
    buffer_load_dword v180, v2, s[16:19], s24 offen offset:2064 nt
    buffer_load_dwordx4 v[184:187], v2, s[16:19], s24 offen offset:3072 nt
    buffer_load_dword v188, v2, s[16:19], s24 offen offset:3088 nt
    s_waitcnt vmcnt(0)
    s_cmp_eq_u32 s3, 7
    s_cbranch_scc0 L_B_noprep
    v_mov_b32 v244, 0
    s_mov_b32 s67, 0
L_wdbg_4:
    global_load_dword v245, v244, s[60:61] sc0 sc1
    s_waitcnt vmcnt(0)
    v_readfirstlane_b32 s66, v245
    s_cmp_lg_u32 s66, 0
    s_cbranch_scc1 L_wdbg_4_ok
    s_sleep 1
    s_add_u32 s67, s67, 1
    s_cmp_lt_u32 s67, 100000
    s_cbranch_scc1 L_wdbg_4
L_wdbg_4_ok:
L_B_noprep:
    s_barrier
    s_cmp_eq_u32 s3, 7
    s_cbranch_scc0 L_B_geom
    s_lshl_b32 s66, s20, 6
    s_add_u32 s66, s66, 7143424
    v_mov_b32 v244, s66
    v_mov_b32 v245, 1
    s_mov_b64 exec, 1
    global_store_dword v244, v245, s[62:63] sc0 sc1
    s_mov_b64 exec, -1
L_B_geom:
    s_cmp_ge_u32 s3, 4
    s_cbranch_scc0 L_B_nobuild
    s_and_b32 s21, s20, 7
    s_mul_i32 s21, s21, 9
    s_lshr_b32 s22, s20, 3
    s_add_u32 s21, s21, s22
    s_lshl_b32 s22, s21, 3
    s_add_u32 s22, s22, s3
    s_mul_i32 s23, s3, 13056
    s_lshl_b32 s24, s22, 12
    s_sub_u32 s27, s23, 52224
    v_lshlrev_b32 v2, 4, v1
    v_mov_b32 v4, 0
    v_mov_b32 v5, 0
    v_mov_b32 v6, 0
    v_mov_b32 v7, 0
    v_add_u32 v3, s27, v2
    s_mov_b32 exec_lo, -1
    s_mov_b32 exec_hi, 0
    ds_write_b128 v3, v[4:7] offset:12416
    s_mov_b64 exec, 3
    ds_write_b128 v3, v[4:7] offset:0
    ds_write_b128 v3, v[4:7] offset:4160
    s_mov_b64 exec, -1
    ds_write_b128 v3, v[128:131] offset:32
    v_alignbit_b32 v96, v129, v128, 16
    v_alignbit_b32 v97, v130, v129, 16
    v_alignbit_b32 v98, v131, v130, 16
    v_alignbit_b32 v99, v132, v131, 16
    ds_write_b128 v3, v[96:99] offset:4192
    ds_write_b128 v3, v[136:139] offset:1056
    v_alignbit_b32 v100, v137, v136, 16
    v_alignbit_b32 v101, v138, v137, 16
    v_alignbit_b32 v102, v139, v138, 16
    v_alignbit_b32 v103, v140, v139, 16
    ds_write_b128 v3, v[100:103] offset:5216
    ds_write_b128 v3, v[144:147] offset:2080
    v_alignbit_b32 v96, v145, v144, 16
    v_alignbit_b32 v97, v146, v145, 16
    v_alignbit_b32 v98, v147, v146, 16
    v_alignbit_b32 v99, v148, v147, 16
    ds_write_b128 v3, v[96:99] offset:6240
    ds_write_b128 v3, v[152:155] offset:3104
    v_alignbit_b32 v100, v153, v152, 16
    v_alignbit_b32 v101, v154, v153, 16
    v_alignbit_b32 v102, v155, v154, 16
    v_alignbit_b32 v103, v156, v155, 16
    ds_write_b128 v3, v[100:103] offset:7264
    v_lshlrev_b32 v4, 16, v128
    s_mov_b64 exec, 1
    ds_write_b32 v3, v4 offset:4188
    s_mov_b64 exec, -1
    v_lshlrev_b32 v2, 4, v1
    v_mov_b32 v4, 0
    v_mov_b32 v5, 0
    v_mov_b32 v6, 0
    v_mov_b32 v7, 0
    v_add_u32 v3, s23, v2
    s_mov_b32 exec_lo, -1
    s_mov_b32 exec_hi, 0
    ds_write_b128 v3, v[4:7] offset:12416
    s_mov_b64 exec, 3
    ds_write_b128 v3, v[4:7] offset:0
    ds_write_b128 v3, v[4:7] offset:4160
    s_mov_b64 exec, -1
    ds_write_b128 v3, v[160:163] offset:32
    v_alignbit_b32 v96, v161, v160, 16
    v_alignbit_b32 v97, v162, v161, 16
    v_alignbit_b32 v98, v163, v162, 16
    v_alignbit_b32 v99, v164, v163, 16
    ds_write_b128 v3, v[96:99] offset:4192
    ds_write_b128 v3, v[168:171] offset:1056
    v_alignbit_b32 v100, v169, v168, 16
    v_alignbit_b32 v101, v170, v169, 16
    v_alignbit_b32 v102, v171, v170, 16
    v_alignbit_b32 v103, v172, v171, 16
    ds_write_b128 v3, v[100:103] offset:5216
    ds_write_b128 v3, v[176:179] offset:2080
    v_alignbit_b32 v96, v177, v176, 16
    v_alignbit_b32 v97, v178, v177, 16
    v_alignbit_b32 v98, v179, v178, 16
    v_alignbit_b32 v99, v180, v179, 16
    ds_write_b128 v3, v[96:99] offset:6240
    ds_write_b128 v3, v[184:187] offset:3104
    v_alignbit_b32 v100, v185, v184, 16
    v_alignbit_b32 v101, v186, v185, 16
    v_alignbit_b32 v102, v187, v186, 16
    v_alignbit_b32 v103, v188, v187, 16
    ds_write_b128 v3, v[100:103] offset:7264
    v_lshlrev_b32 v4, 16, v160
    s_mov_b64 exec, 1
    ds_write_b32 v3, v4 offset:4188
    s_mov_b64 exec, -1
L_B_nobuild:
    s_and_b32 s21, s20, 7
    s_mul_i32 s21, s21, 9
    s_lshr_b32 s22, s20, 3
    s_add_u32 s21, s21, s22
    s_lshl_b32 s22, s21, 3
    s_add_u32 s22, s22, s3
    s_mul_i32 s23, s3, 13056
    s_lshl_b32 s24, s22, 12
    s_waitcnt lgkmcnt(0)
    v_lshlrev_b32 v2, 4, v1
    v_add_u32 v3, s23, v2
    v_and_b32 v8, 15, v1
    v_lshrrev_b32 v9, 4, v1
    v_lshrrev_b32 v10, 1, v9
    v_and_b32 v11, 1, v9
    v_lshlrev_b32 v12, 4, v10
    v_lshl_add_u32 v12, v11, 3, v12
    v_add_u32 v12, v12, v8
    v_and_b32 v13, 1, v8
    v_add_u32 v12, v12, v13
    v_lshlrev_b32 v12, 1, v12
    v_cmp_eq_u32 vcc, 0, v13
    v_mov_b32 v14, 4160
    v_add_u32 v12, s23, v12
    v_cndmask_b32 v14, 0, v14, vcc
    v_add_u32 v16, v12, v14
    v_add_u32 v17, 1024, v16
    v_add_u32 v18, 2048, v16
    v_add_u32 v19, 3072, v16
    v_sub_u32 v20, v10, v8
    v_lshlrev_b32 v20, 5, v20
    v_lshl_add_u32 v20, v11, 4, v20
    v_add_u32 v20, 8800, v20
    v_add_u32 v20, s23, v20
    s_waitcnt lgkmcnt(0)
    s_and_b32 s25, s22, 1
    s_lshl_b32 s25, s25, 4
    s_lshr_b32 s26, s64, s25
    s_and_b32 s26, s26, 0xffff
    v_sub_u32 v4, 15, v8
    v_lshrrev_b32 v5, 3, v4
    v_and_b32 v4, 7, v4
    v_and_b32 v6, 1, v4
    v_lshlrev_b32 v6, 4, v6
    v_mov_b32 v7, s26
    v_lshlrev_b32 v7, v6, v7
    v_lshrrev_b32 v4, 1, v4
    v_cmp_eq_u32 vcc, v5, v9
    s_nop 1
    v_cndmask_b32 v7, 0, v7, vcc
    v_cmp_eq_u32 vcc, 0, v4
    s_nop 1
    v_cndmask_b32 v24, 0, v7, vcc
    v_cmp_eq_u32 vcc, 1, v4
    s_nop 1
    v_cndmask_b32 v25, 0, v7, vcc
    v_cmp_eq_u32 vcc, 2, v4
    s_nop 1
    v_cndmask_b32 v26, 0, v7, vcc
    v_cmp_eq_u32 vcc, 3, v4
    s_nop 1
    v_cndmask_b32 v27, 0, v7, vcc
    s_cmp_eq_u32 s3, 7
    s_cbranch_scc0 L_B_wait
    s_lshr_b32 s66, s21, 3
    s_lshl_b32 s66, s66, 3
    v_and_b32 v248, 7, v1
    v_add_u32 v248, s66, v248
    v_lshlrev_b32 v248, 6, v248
    v_add_u32 v248, 7143424, v248
    s_mov_b32 s67, 0
L_poll_5:
    global_load_dword v246, v248, s[62:63] sc0 sc1
    s_waitcnt vmcnt(0)
    v_cmp_eq_u32 vcc, 0, v246
    s_nop 1
    s_cmp_eq_u64 vcc, 0
    s_cbranch_scc1 L_poll_5_ok
    s_sleep 1
    s_add_u32 s67, s67, 1
    s_cmp_lt_u32 s67, 100000
    s_cbranch_scc1 L_poll_5
L_poll_5_ok:
L_B_wait:
    s_barrier
    s_mov_b32 s12, s62
    s_and_b32 s13, s63, 0xffff
    s_mov_b32 s14, 8388608
    s_mov_b32 s15, 0x20000
    buffer_load_dwordx4 v[64:67], v2, s[12:15], s24 offen offset:0 sc1
    buffer_load_dwordx4 v[68:71], v2, s[12:15], s24 offen offset:1024 sc1
    buffer_load_dwordx4 v[72:75], v2, s[12:15], s24 offen offset:2048 sc1
    buffer_load_dwordx4 v[76:79], v2, s[12:15], s24 offen offset:3072 sc1
    s_waitcnt vmcnt(0)
    ds_write_b128 v3, v[64:67] offset:8320
    ds_write_b128 v3, v[68:71] offset:9344
    ds_write_b128 v3, v[72:75] offset:10368
    ds_write_b128 v3, v[76:79] offset:11392
    s_mov_b32 s16, s46
    s_and_b32 s17, s47, 0xffff
    s_mov_b32 s18, 2359296
    s_mov_b32 s19, 0x20000
    v_mul_u32_u24 v4, 4608, v0
    s_lshl_b32 s27, s21, 4
    v_mov_b32 v21, v4
    s_waitcnt lgkmcnt(0)
    ds_read_b128 v[96:99], v20 offset:3584
    ds_read2_b32 v[64:65], v16 offset0:0 offset1:1
    ds_read2_b32 v[66:67], v16 offset0:2 offset1:3
    ds_read_b128 v[100:103], v20 offset:3072
    ds_read2_b32 v[68:69], v16 offset0:128 offset1:129
    ds_read2_b32 v[70:71], v16 offset0:130 offset1:131
    ds_read_b128 v[104:107], v20 offset:2560
    ds_read2_b32 v[72:73], v17 offset0:0 offset1:1
    ds_read2_b32 v[74:75], v17 offset0:2 offset1:3
    ds_read_b128 v[108:111], v20 offset:2048
    ds_read2_b32 v[76:77], v17 offset0:128 offset1:129
    ds_read2_b32 v[78:79], v17 offset0:130 offset1:131
    ds_read_b128 v[112:115], v20 offset:1536
    ds_read2_b32 v[80:81], v18 offset0:0 offset1:1
    ds_read2_b32 v[82:83], v18 offset0:2 offset1:3
    ds_read_b128 v[116:119], v20 offset:1024
    ds_read2_b32 v[84:85], v18 offset0:128 offset1:129
    ds_read2_b32 v[86:87], v18 offset0:130 offset1:131
    ds_read_b128 v[120:123], v20 offset:512
    ds_read2_b32 v[88:89], v19 offset0:0 offset1:1
    ds_read2_b32 v[90:91], v19 offset0:2 offset1:3
    ds_read_b128 v[124:127], v20 offset:0
    ds_read2_b32 v[92:93], v19 offset0:128 offset1:129
    ds_read2_b32 v[94:95], v19 offset0:130 offset1:131
    v_add_u32 v16, 64, v16
    v_add_u32 v17, 64, v17
    v_add_u32 v18, 64, v18
    v_add_u32 v19, 64, v19
    v_add_u32 v20, 64, v20
    s_waitcnt lgkmcnt(0)
    v_mfma_f32_16x16x32_bf16 v[32:35], v[24:27], v[96:99], 0
    v_mfma_f32_16x16x32_bf16 v[36:39], v[24:27], v[100:103], 0
    v_mfma_f32_16x16x32_bf16 v[40:43], v[24:27], v[104:107], 0
    v_mfma_f32_16x16x32_bf16 v[44:47], v[24:27], v[108:111], 0
    v_mfma_f32_16x16x32_bf16 v[48:51], v[24:27], v[112:115], 0
    v_mfma_f32_16x16x32_bf16 v[52:55], v[24:27], v[116:119], 0
    v_mfma_f32_16x16x32_bf16 v[56:59], v[24:27], v[120:123], 0
    v_mfma_f32_16x16x32_bf16 v[60:63], v[24:27], v[124:127], 0
    s_mov_b32 s28, 0
L_conv_loop:
    s_cmp_lt_u32 s3, 4
    s_cbranch_scc0 L_ql_6
    s_cmp_eq_u32 s28, 0
    s_cbranch_scc0 L_qr_7
    buffer_load_dwordx4 v[224:227], v21, s[16:19], s27 offen offset:0 nt
L_qr_7:
    s_cmp_eq_u32 s28, 1
    s_cbranch_scc0 L_qr_8
    buffer_load_dwordx4 v[228:231], v21, s[16:19], s27 offen offset:1152 nt
L_qr_8:
    s_cmp_eq_u32 s28, 2
    s_cbranch_scc0 L_qr_9
    buffer_load_dwordx4 v[232:235], v21, s[16:19], s27 offen offset:2304 nt
L_qr_9:
L_ql_6:
    ds_read_b128 v[160:163], v20 offset:3584
    v_mfma_f32_16x16x32_bf16 v[32:35], v[64:67], v[96:99], v[32:35]
    ds_read2_b32 v[128:129], v16 offset0:0 offset1:1
    v_mfma_f32_16x16x32_bf16 v[36:39], v[68:71], v[96:99], v[36:39]
    ds_read2_b32 v[130:131], v16 offset0:2 offset1:3
    v_mfma_f32_16x16x32_bf16 v[36:39], v[64:67], v[100:103], v[36:39]
    ds_read_b128 v[164:167], v20 offset:3072
    v_mfma_f32_16x16x32_bf16 v[40:43], v[68:71], v[100:103], v[40:43]
    ds_read2_b32 v[132:133], v16 offset0:128 offset1:129
    v_mfma_f32_16x16x32_bf16 v[40:43], v[72:75], v[96:99], v[40:43]
    ds_read2_b32 v[134:135], v16 offset0:130 offset1:131
    v_mfma_f32_16x16x32_bf16 v[40:43], v[64:67], v[104:107], v[40:43]
    ds_read_b128 v[168:171], v20 offset:2560
    v_mfma_f32_16x16x32_bf16 v[44:47], v[72:75], v[100:103], v[44:47]
    ds_read2_b32 v[136:137], v17 offset0:0 offset1:1
    v_mfma_f32_16x16x32_bf16 v[44:47], v[68:71], v[104:107], v[44:47]
    ds_read2_b32 v[138:139], v17 offset0:2 offset1:3
    v_mfma_f32_16x16x32_bf16 v[48:51], v[72:75], v[104:107], v[48:51]
    ds_read_b128 v[172:175], v20 offset:2048
    v_mfma_f32_16x16x32_bf16 v[44:47], v[76:79], v[96:99], v[44:47]
    ds_read2_b32 v[140:141], v17 offset0:128 offset1:129
    v_mfma_f32_16x16x32_bf16 v[44:47], v[64:67], v[108:111], v[44:47]
    ds_read2_b32 v[142:143], v17 offset0:130 offset1:131
    v_mfma_f32_16x16x32_bf16 v[48:51], v[76:79], v[100:103], v[48:51]
    ds_read_b128 v[176:179], v20 offset:1536
    v_mfma_f32_16x16x32_bf16 v[48:51], v[68:71], v[108:111], v[48:51]
    ds_read2_b32 v[144:145], v18 offset0:0 offset1:1
    v_mfma_f32_16x16x32_bf16 v[52:55], v[76:79], v[104:107], v[52:55]
    ds_read2_b32 v[146:147], v18 offset0:2 offset1:3
    v_mfma_f32_16x16x32_bf16 v[52:55], v[72:75], v[108:111], v[52:55]
    ds_read_b128 v[180:183], v20 offset:1024
    v_mfma_f32_16x16x32_bf16 v[56:59], v[76:79], v[108:111], v[56:59]
    ds_read2_b32 v[148:149], v18 offset0:128 offset1:129
    v_mfma_f32_16x16x32_bf16 v[48:51], v[80:83], v[96:99], v[48:51]
    ds_read2_b32 v[150:151], v18 offset0:130 offset1:131
    v_mfma_f32_16x16x32_bf16 v[48:51], v[64:67], v[112:115], v[48:51]
    ds_read_b128 v[184:187], v20 offset:512
    v_mfma_f32_16x16x32_bf16 v[52:55], v[80:83], v[100:103], v[52:55]
    ds_read2_b32 v[152:153], v19 offset0:0 offset1:1
    v_mfma_f32_16x16x32_bf16 v[52:55], v[68:71], v[112:115], v[52:55]
    ds_read2_b32 v[154:155], v19 offset0:2 offset1:3
    v_mfma_f32_16x16x32_bf16 v[56:59], v[80:83], v[104:107], v[56:59]
    ds_read_b128 v[188:191], v20 offset:0
    v_mfma_f32_16x16x32_bf16 v[56:59], v[72:75], v[112:115], v[56:59]
    ds_read2_b32 v[156:157], v19 offset0:128 offset1:129
    v_mfma_f32_16x16x32_bf16 v[60:63], v[80:83], v[108:111], v[60:63]
    ds_read2_b32 v[158:159], v19 offset0:130 offset1:131
    v_mfma_f32_16x16x32_bf16 v[60:63], v[76:79], v[112:115], v[60:63]
    v_mfma_f32_16x16x32_bf16 v[52:55], v[84:87], v[96:99], v[52:55]
    v_mfma_f32_16x16x32_bf16 v[52:55], v[64:67], v[116:119], v[52:55]
    v_mfma_f32_16x16x32_bf16 v[56:59], v[84:87], v[100:103], v[56:59]
    v_mfma_f32_16x16x32_bf16 v[56:59], v[68:71], v[116:119], v[56:59]
    v_mfma_f32_16x16x32_bf16 v[60:63], v[84:87], v[104:107], v[60:63]
    v_mfma_f32_16x16x32_bf16 v[60:63], v[72:75], v[116:119], v[60:63]
    v_mfma_f32_16x16x32_bf16 v[56:59], v[88:91], v[96:99], v[56:59]
    v_mfma_f32_16x16x32_bf16 v[56:59], v[64:67], v[120:123], v[56:59]
    v_mfma_f32_16x16x32_bf16 v[60:63], v[88:91], v[100:103], v[60:63]
    v_mfma_f32_16x16x32_bf16 v[60:63], v[68:71], v[120:123], v[60:63]
    v_mfma_f32_16x16x32_bf16 v[60:63], v[92:95], v[96:99], v[60:63]
    v_mfma_f32_16x16x32_bf16 v[60:63], v[64:67], v[124:127], v[60:63]
    v_add_u32 v16, 64, v16
    v_add_u32 v17, 64, v17
    v_add_u32 v18, 64, v18
    v_add_u32 v19, 64, v19
    v_add_u32 v20, 64, v20
    s_waitcnt lgkmcnt(0)
    s_cmp_lt_u32 s3, 4
    s_cbranch_scc1 L_ql_10
    s_cmp_eq_u32 s28, 0
    s_cbranch_scc0 L_qr_11
    buffer_load_dwordx4 v[224:227], v21, s[16:19], s27 offen offset:0 nt
L_qr_11:
    s_cmp_eq_u32 s28, 1
    s_cbranch_scc0 L_qr_12
    buffer_load_dwordx4 v[228:231], v21, s[16:19], s27 offen offset:1152 nt
L_qr_12:
    s_cmp_eq_u32 s28, 2
    s_cbranch_scc0 L_qr_13
    buffer_load_dwordx4 v[232:235], v21, s[16:19], s27 offen offset:2304 nt
L_qr_13:
L_ql_10:
    ds_read_b128 v[96:99], v20 offset:3584
    v_mfma_f32_16x16x32_bf16 v[32:35], v[128:131], v[160:163], v[32:35]
    ds_read2_b32 v[64:65], v16 offset0:0 offset1:1
    v_mfma_f32_16x16x32_bf16 v[36:39], v[132:135], v[160:163], v[36:39]
    ds_read2_b32 v[66:67], v16 offset0:2 offset1:3
    v_mfma_f32_16x16x32_bf16 v[36:39], v[128:131], v[164:167], v[36:39]
    ds_read_b128 v[100:103], v20 offset:3072
    v_mfma_f32_16x16x32_bf16 v[40:43], v[132:135], v[164:167], v[40:43]
    ds_read2_b32 v[68:69], v16 offset0:128 offset1:129
    v_mfma_f32_16x16x32_bf16 v[40:43], v[136:139], v[160:163], v[40:43]
    ds_read2_b32 v[70:71], v16 offset0:130 offset1:131
    v_mfma_f32_16x16x32_bf16 v[40:43], v[128:131], v[168:171], v[40:43]
    ds_read_b128 v[104:107], v20 offset:2560
    v_mfma_f32_16x16x32_bf16 v[44:47], v[136:139], v[164:167], v[44:47]
    ds_read2_b32 v[72:73], v17 offset0:0 offset1:1
    v_mfma_f32_16x16x32_bf16 v[44:47], v[132:135], v[168:171], v[44:47]
    ds_read2_b32 v[74:75], v17 offset0:2 offset1:3
    v_mfma_f32_16x16x32_bf16 v[48:51], v[136:139], v[168:171], v[48:51]
    ds_read_b128 v[108:111], v20 offset:2048
    v_mfma_f32_16x16x32_bf16 v[44:47], v[140:143], v[160:163], v[44:47]
    ds_read2_b32 v[76:77], v17 offset0:128 offset1:129
    v_mfma_f32_16x16x32_bf16 v[44:47], v[128:131], v[172:175], v[44:47]
    ds_read2_b32 v[78:79], v17 offset0:130 offset1:131
    v_mfma_f32_16x16x32_bf16 v[48:51], v[140:143], v[164:167], v[48:51]
    ds_read_b128 v[112:115], v20 offset:1536
    v_mfma_f32_16x16x32_bf16 v[48:51], v[132:135], v[172:175], v[48:51]
    ds_read2_b32 v[80:81], v18 offset0:0 offset1:1
    v_mfma_f32_16x16x32_bf16 v[52:55], v[140:143], v[168:171], v[52:55]
    ds_read2_b32 v[82:83], v18 offset0:2 offset1:3
    v_mfma_f32_16x16x32_bf16 v[52:55], v[136:139], v[172:175], v[52:55]
    ds_read_b128 v[116:119], v20 offset:1024
    v_mfma_f32_16x16x32_bf16 v[56:59], v[140:143], v[172:175], v[56:59]
    ds_read2_b32 v[84:85], v18 offset0:128 offset1:129
    v_mfma_f32_16x16x32_bf16 v[48:51], v[144:147], v[160:163], v[48:51]
    ds_read2_b32 v[86:87], v18 offset0:130 offset1:131
    v_mfma_f32_16x16x32_bf16 v[48:51], v[128:131], v[176:179], v[48:51]
    ds_read_b128 v[120:123], v20 offset:512
    v_mfma_f32_16x16x32_bf16 v[52:55], v[144:147], v[164:167], v[52:55]
    ds_read2_b32 v[88:89], v19 offset0:0 offset1:1
    v_mfma_f32_16x16x32_bf16 v[52:55], v[132:135], v[176:179], v[52:55]
    ds_read2_b32 v[90:91], v19 offset0:2 offset1:3
    v_mfma_f32_16x16x32_bf16 v[56:59], v[144:147], v[168:171], v[56:59]
    ds_read_b128 v[124:127], v20 offset:0
    v_mfma_f32_16x16x32_bf16 v[56:59], v[136:139], v[176:179], v[56:59]
    ds_read2_b32 v[92:93], v19 offset0:128 offset1:129
    v_mfma_f32_16x16x32_bf16 v[60:63], v[144:147], v[172:175], v[60:63]
    ds_read2_b32 v[94:95], v19 offset0:130 offset1:131
    v_mfma_f32_16x16x32_bf16 v[60:63], v[140:143], v[176:179], v[60:63]
    v_mfma_f32_16x16x32_bf16 v[52:55], v[148:151], v[160:163], v[52:55]
    v_mfma_f32_16x16x32_bf16 v[52:55], v[128:131], v[180:183], v[52:55]
    v_mfma_f32_16x16x32_bf16 v[56:59], v[148:151], v[164:167], v[56:59]
    v_mfma_f32_16x16x32_bf16 v[56:59], v[132:135], v[180:183], v[56:59]
    v_mfma_f32_16x16x32_bf16 v[60:63], v[148:151], v[168:171], v[60:63]
    v_mfma_f32_16x16x32_bf16 v[60:63], v[136:139], v[180:183], v[60:63]
    v_mfma_f32_16x16x32_bf16 v[56:59], v[152:155], v[160:163], v[56:59]
    v_mfma_f32_16x16x32_bf16 v[56:59], v[128:131], v[184:187], v[56:59]
    v_mfma_f32_16x16x32_bf16 v[60:63], v[152:155], v[164:167], v[60:63]
    v_mfma_f32_16x16x32_bf16 v[60:63], v[132:135], v[184:187], v[60:63]
    v_mfma_f32_16x16x32_bf16 v[60:63], v[156:159], v[160:163], v[60:63]
    v_mfma_f32_16x16x32_bf16 v[60:63], v[128:131], v[188:191], v[60:63]
    v_add_u32 v16, 64, v16
    v_add_u32 v17, 64, v17
    v_add_u32 v18, 64, v18
    v_add_u32 v19, 64, v19
    v_add_u32 v20, 64, v20
    s_waitcnt lgkmcnt(0)
    s_add_u32 s28, s28, 1
    s_cmp_lt_u32 s28, 3
    s_cbranch_scc1 L_conv_loop
    s_cmp_lt_u32 s3, 4
    s_cbranch_scc0 L_ql_14
    buffer_load_dwordx4 v[236:239], v21, s[16:19], s27 offen offset:3456 nt
L_ql_14:
    ds_read_b128 v[160:163], v20 offset:3584
    v_mfma_f32_16x16x32_bf16 v[32:35], v[64:67], v[96:99], v[32:35]
    ds_read2_b32 v[128:129], v16 offset0:0 offset1:1
    v_mfma_f32_16x16x32_bf16 v[36:39], v[68:71], v[96:99], v[36:39]
    ds_read2_b32 v[130:131], v16 offset0:2 offset1:3
    v_mfma_f32_16x16x32_bf16 v[36:39], v[64:67], v[100:103], v[36:39]
    ds_read_b128 v[164:167], v20 offset:3072
    v_mfma_f32_16x16x32_bf16 v[40:43], v[68:71], v[100:103], v[40:43]
    ds_read2_b32 v[132:133], v16 offset0:128 offset1:129
    v_mfma_f32_16x16x32_bf16 v[40:43], v[72:75], v[96:99], v[40:43]
    ds_read2_b32 v[134:135], v16 offset0:130 offset1:131
    v_mfma_f32_16x16x32_bf16 v[40:43], v[64:67], v[104:107], v[40:43]
    ds_read_b128 v[168:171], v20 offset:2560
    v_mfma_f32_16x16x32_bf16 v[44:47], v[72:75], v[100:103], v[44:47]
    ds_read2_b32 v[136:137], v17 offset0:0 offset1:1
    v_mfma_f32_16x16x32_bf16 v[44:47], v[68:71], v[104:107], v[44:47]
    ds_read2_b32 v[138:139], v17 offset0:2 offset1:3
    v_mfma_f32_16x16x32_bf16 v[48:51], v[72:75], v[104:107], v[48:51]
    ds_read_b128 v[172:175], v20 offset:2048
    v_mfma_f32_16x16x32_bf16 v[44:47], v[76:79], v[96:99], v[44:47]
    ds_read2_b32 v[140:141], v17 offset0:128 offset1:129
    v_mfma_f32_16x16x32_bf16 v[44:47], v[64:67], v[108:111], v[44:47]
    ds_read2_b32 v[142:143], v17 offset0:130 offset1:131
    v_mfma_f32_16x16x32_bf16 v[48:51], v[76:79], v[100:103], v[48:51]
    ds_read_b128 v[176:179], v20 offset:1536
    v_mfma_f32_16x16x32_bf16 v[48:51], v[68:71], v[108:111], v[48:51]
    ds_read2_b32 v[144:145], v18 offset0:0 offset1:1
    v_mfma_f32_16x16x32_bf16 v[52:55], v[76:79], v[104:107], v[52:55]
    ds_read2_b32 v[146:147], v18 offset0:2 offset1:3
    v_mfma_f32_16x16x32_bf16 v[52:55], v[72:75], v[108:111], v[52:55]
    ds_read_b128 v[180:183], v20 offset:1024
    v_mfma_f32_16x16x32_bf16 v[56:59], v[76:79], v[108:111], v[56:59]
    ds_read2_b32 v[148:149], v18 offset0:128 offset1:129
    v_mfma_f32_16x16x32_bf16 v[48:51], v[80:83], v[96:99], v[48:51]
    ds_read2_b32 v[150:151], v18 offset0:130 offset1:131
    v_mfma_f32_16x16x32_bf16 v[48:51], v[64:67], v[112:115], v[48:51]
    ds_read_b128 v[184:187], v20 offset:512
    v_mfma_f32_16x16x32_bf16 v[52:55], v[80:83], v[100:103], v[52:55]
    ds_read2_b32 v[152:153], v19 offset0:0 offset1:1
    v_mfma_f32_16x16x32_bf16 v[52:55], v[68:71], v[112:115], v[52:55]
    ds_read2_b32 v[154:155], v19 offset0:2 offset1:3
    v_mfma_f32_16x16x32_bf16 v[56:59], v[80:83], v[104:107], v[56:59]
    ds_read_b128 v[188:191], v20 offset:0
    v_mfma_f32_16x16x32_bf16 v[56:59], v[72:75], v[112:115], v[56:59]
    ds_read2_b32 v[156:157], v19 offset0:128 offset1:129
    v_mfma_f32_16x16x32_bf16 v[60:63], v[80:83], v[108:111], v[60:63]
    ds_read2_b32 v[158:159], v19 offset0:130 offset1:131
    v_mfma_f32_16x16x32_bf16 v[60:63], v[76:79], v[112:115], v[60:63]
    v_mfma_f32_16x16x32_bf16 v[52:55], v[84:87], v[96:99], v[52:55]
    v_mfma_f32_16x16x32_bf16 v[52:55], v[64:67], v[116:119], v[52:55]
    v_mfma_f32_16x16x32_bf16 v[56:59], v[84:87], v[100:103], v[56:59]
    v_mfma_f32_16x16x32_bf16 v[56:59], v[68:71], v[116:119], v[56:59]
    v_mfma_f32_16x16x32_bf16 v[60:63], v[84:87], v[104:107], v[60:63]
    v_mfma_f32_16x16x32_bf16 v[60:63], v[72:75], v[116:119], v[60:63]
    v_mfma_f32_16x16x32_bf16 v[56:59], v[88:91], v[96:99], v[56:59]
    v_mfma_f32_16x16x32_bf16 v[56:59], v[64:67], v[120:123], v[56:59]
    v_mfma_f32_16x16x32_bf16 v[60:63], v[88:91], v[100:103], v[60:63]
    v_mfma_f32_16x16x32_bf16 v[60:63], v[68:71], v[120:123], v[60:63]
    v_mfma_f32_16x16x32_bf16 v[60:63], v[92:95], v[96:99], v[60:63]
    v_mfma_f32_16x16x32_bf16 v[60:63], v[64:67], v[124:127], v[60:63]
    v_add_u32 v16, 64, v16
    v_add_u32 v17, 64, v17
    v_add_u32 v18, 64, v18
    v_add_u32 v19, 64, v19
    v_add_u32 v20, 64, v20
    s_waitcnt lgkmcnt(0)
    s_cmp_lt_u32 s3, 4
    s_cbranch_scc1 L_ql_15
    buffer_load_dwordx4 v[236:239], v21, s[16:19], s27 offen offset:3456 nt
L_ql_15:
    v_mfma_f32_16x16x32_bf16 v[32:35], v[128:131], v[160:163], v[32:35]
    v_mfma_f32_16x16x32_bf16 v[36:39], v[132:135], v[160:163], v[36:39]
    v_mfma_f32_16x16x32_bf16 v[36:39], v[128:131], v[164:167], v[36:39]
    v_mfma_f32_16x16x32_bf16 v[40:43], v[132:135], v[164:167], v[40:43]
    v_mfma_f32_16x16x32_bf16 v[40:43], v[136:139], v[160:163], v[40:43]
    v_mfma_f32_16x16x32_bf16 v[40:43], v[128:131], v[168:171], v[40:43]
    v_mfma_f32_16x16x32_bf16 v[44:47], v[136:139], v[164:167], v[44:47]
    v_mfma_f32_16x16x32_bf16 v[44:47], v[132:135], v[168:171], v[44:47]
    v_mfma_f32_16x16x32_bf16 v[48:51], v[136:139], v[168:171], v[48:51]
    v_mfma_f32_16x16x32_bf16 v[44:47], v[140:143], v[160:163], v[44:47]
    v_mfma_f32_16x16x32_bf16 v[44:47], v[128:131], v[172:175], v[44:47]
    v_mfma_f32_16x16x32_bf16 v[48:51], v[140:143], v[164:167], v[48:51]
    v_mfma_f32_16x16x32_bf16 v[48:51], v[132:135], v[172:175], v[48:51]
    v_mfma_f32_16x16x32_bf16 v[52:55], v[140:143], v[168:171], v[52:55]
    v_mfma_f32_16x16x32_bf16 v[52:55], v[136:139], v[172:175], v[52:55]
    v_mfma_f32_16x16x32_bf16 v[56:59], v[140:143], v[172:175], v[56:59]
    v_mfma_f32_16x16x32_bf16 v[48:51], v[144:147], v[160:163], v[48:51]
    v_mfma_f32_16x16x32_bf16 v[48:51], v[128:131], v[176:179], v[48:51]
    v_mfma_f32_16x16x32_bf16 v[52:55], v[144:147], v[164:167], v[52:55]
    v_mfma_f32_16x16x32_bf16 v[52:55], v[132:135], v[176:179], v[52:55]
    v_mfma_f32_16x16x32_bf16 v[56:59], v[144:147], v[168:171], v[56:59]
    v_mfma_f32_16x16x32_bf16 v[56:59], v[136:139], v[176:179], v[56:59]
    v_mfma_f32_16x16x32_bf16 v[60:63], v[144:147], v[172:175], v[60:63]
    v_mfma_f32_16x16x32_bf16 v[60:63], v[140:143], v[176:179], v[60:63]
    v_mfma_f32_16x16x32_bf16 v[52:55], v[148:151], v[160:163], v[52:55]
    v_mfma_f32_16x16x32_bf16 v[52:55], v[128:131], v[180:183], v[52:55]
    v_mfma_f32_16x16x32_bf16 v[56:59], v[148:151], v[164:167], v[56:59]
    v_mfma_f32_16x16x32_bf16 v[56:59], v[132:135], v[180:183], v[56:59]
    v_mfma_f32_16x16x32_bf16 v[60:63], v[148:151], v[168:171], v[60:63]
    v_mfma_f32_16x16x32_bf16 v[60:63], v[136:139], v[180:183], v[60:63]
    v_mfma_f32_16x16x32_bf16 v[56:59], v[152:155], v[160:163], v[56:59]
    v_mfma_f32_16x16x32_bf16 v[56:59], v[128:131], v[184:187], v[56:59]
    v_mfma_f32_16x16x32_bf16 v[60:63], v[152:155], v[164:167], v[60:63]
    v_mfma_f32_16x16x32_bf16 v[60:63], v[132:135], v[184:187], v[60:63]
    v_mfma_f32_16x16x32_bf16 v[60:63], v[156:159], v[160:163], v[60:63]
    v_mfma_f32_16x16x32_bf16 v[60:63], v[128:131], v[188:191], v[60:63]
    v_lshrrev_b32 v5, 2, v8
    v_xor_b32 v5, v5, v9
    v_lshlrev_b32 v4, 2, v8
    v_add_u32 v4, v4, v5
    v_lshlrev_b32 v4, 3, v4
    s_lshl_b32 s25, s3, 12
    s_add_u32 s25, s25, 104448
    v_add_u32 v4, s25, v4
    v_mov_b32 v14, 0xffff0000
    v_cvt_pk_bf16_f32 v64, v32, v33
    v_cvt_pk_bf16_f32 v65, v34, v35
    ds_write_b64 v4, v[64:65] offset:0
    v_cvt_pk_bf16_f32 v66, v36, v37
    v_cvt_pk_bf16_f32 v67, v38, v39
    ds_write_b64 v4, v[66:67] offset:512
    v_cvt_pk_bf16_f32 v68, v40, v41
    v_cvt_pk_bf16_f32 v69, v42, v43
    ds_write_b64 v4, v[68:69] offset:1024
    v_cvt_pk_bf16_f32 v70, v44, v45
    v_cvt_pk_bf16_f32 v71, v46, v47
    ds_write_b64 v4, v[70:71] offset:1536
    v_cvt_pk_bf16_f32 v64, v48, v49
    v_cvt_pk_bf16_f32 v65, v50, v51
    ds_write_b64 v4, v[64:65] offset:2048
    v_cvt_pk_bf16_f32 v66, v52, v53
    v_cvt_pk_bf16_f32 v67, v54, v55
    ds_write_b64 v4, v[66:67] offset:2560
    v_cvt_pk_bf16_f32 v68, v56, v57
    v_cvt_pk_bf16_f32 v69, v58, v59
    ds_write_b64 v4, v[68:69] offset:3072
    v_cvt_pk_bf16_f32 v70, v60, v61
    v_cvt_pk_bf16_f32 v71, v62, v63
    ds_write_b64 v4, v[70:71] offset:3584
    s_waitcnt lgkmcnt(0)
    s_barrier
    v_bfe_u32 v5, v0, 4, 2
    v_xor_b32 v4, v5, v0
    v_lshlrev_b32 v4, 3, v4
    v_add_u32 v4, 104448, v4
    ds_read_b64 v[64:65], v4 offset:0
    ds_read_b64 v[66:67], v4 offset:4096
    ds_read_b64 v[68:69], v4 offset:8192
    ds_read_b64 v[70:71], v4 offset:12288
    ds_read_b64 v[72:73], v4 offset:16384
    ds_read_b64 v[74:75], v4 offset:20480
    ds_read_b64 v[76:77], v4 offset:24576
    ds_read_b64 v[78:79], v4 offset:28672
    s_mov_b32 s16, s58
    s_and_b32 s17, s59, 0xffff
    s_mov_b32 s18, 4718592
    s_mov_b32 s19, 0x20000
    v_mul_u32_u24 v5, 9216, v0
    s_lshl_b32 s25, s21, 4
    s_add_u32 s25, s25, 1152
    s_waitcnt vmcnt(0) lgkmcnt(0)
    v_lshlrev_b32 v112, 16, v64
    v_lshlrev_b32 v113, 16, v66
    v_lshlrev_b32 v114, 16, v224
    v_and_b32 v115, v14, v224
    v_pk_mul_f32 v[112:113], v[112:113], v[114:115]
    v_cvt_pk_bf16_f32 v96, v112, v113
    v_lshlrev_b32 v116, 16, v68
    v_lshlrev_b32 v117, 16, v70
    v_lshlrev_b32 v118, 16, v225
    v_and_b32 v119, v14, v225
    v_pk_mul_f32 v[116:117], v[116:117], v[118:119]
    v_cvt_pk_bf16_f32 v97, v116, v117
    v_lshlrev_b32 v112, 16, v72
    v_lshlrev_b32 v113, 16, v74
    v_lshlrev_b32 v114, 16, v226
    v_and_b32 v115, v14, v226
    v_pk_mul_f32 v[112:113], v[112:113], v[114:115]
    v_cvt_pk_bf16_f32 v98, v112, v113
    v_lshlrev_b32 v116, 16, v76
    v_lshlrev_b32 v117, 16, v78
    v_lshlrev_b32 v118, 16, v227
    v_and_b32 v119, v14, v227
    v_pk_mul_f32 v[116:117], v[116:117], v[118:119]
    v_cvt_pk_bf16_f32 v99, v116, v117
    buffer_store_dwordx4 v[96:99], v5, s[16:19], s25 offen
    v_and_b32 v112, v14, v64
    v_and_b32 v113, v14, v66
    v_lshlrev_b32 v114, 16, v228
    v_and_b32 v115, v14, v228
    v_pk_mul_f32 v[112:113], v[112:113], v[114:115]
    v_cvt_pk_bf16_f32 v100, v112, v113
    v_and_b32 v116, v14, v68
    v_and_b32 v117, v14, v70
    v_lshlrev_b32 v118, 16, v229
    v_and_b32 v119, v14, v229
    v_pk_mul_f32 v[116:117], v[116:117], v[118:119]
    v_cvt_pk_bf16_f32 v101, v116, v117
    v_and_b32 v112, v14, v72
    v_and_b32 v113, v14, v74
    v_lshlrev_b32 v114, 16, v230
    v_and_b32 v115, v14, v230
    v_pk_mul_f32 v[112:113], v[112:113], v[114:115]
    v_cvt_pk_bf16_f32 v102, v112, v113
    v_and_b32 v116, v14, v76
    v_and_b32 v117, v14, v78
    v_lshlrev_b32 v118, 16, v231
    v_and_b32 v119, v14, v231
    v_pk_mul_f32 v[116:117], v[116:117], v[118:119]
    v_cvt_pk_bf16_f32 v103, v116, v117
    buffer_store_dwordx4 v[100:103], v5, s[16:19], s25 offen offset:2304
    v_lshlrev_b32 v112, 16, v65
    v_lshlrev_b32 v113, 16, v67
    v_lshlrev_b32 v114, 16, v232
    v_and_b32 v115, v14, v232
    v_pk_mul_f32 v[112:113], v[112:113], v[114:115]
    v_cvt_pk_bf16_f32 v104, v112, v113
    v_lshlrev_b32 v116, 16, v69
    v_lshlrev_b32 v117, 16, v71
    v_lshlrev_b32 v118, 16, v233
    v_and_b32 v119, v14, v233
    v_pk_mul_f32 v[116:117], v[116:117], v[118:119]
    v_cvt_pk_bf16_f32 v105, v116, v117
    v_lshlrev_b32 v112, 16, v73
    v_lshlrev_b32 v113, 16, v75
    v_lshlrev_b32 v114, 16, v234
    v_and_b32 v115, v14, v234
    v_pk_mul_f32 v[112:113], v[112:113], v[114:115]
    v_cvt_pk_bf16_f32 v106, v112, v113
    v_lshlrev_b32 v116, 16, v77
    v_lshlrev_b32 v117, 16, v79
    v_lshlrev_b32 v118, 16, v235
    v_and_b32 v119, v14, v235
    v_pk_mul_f32 v[116:117], v[116:117], v[118:119]
    v_cvt_pk_bf16_f32 v107, v116, v117
    s_add_u32 s25, s25, 4608
    buffer_store_dwordx4 v[104:107], v5, s[16:19], s25 offen offset:0
    v_and_b32 v112, v14, v65
    v_and_b32 v113, v14, v67
    v_lshlrev_b32 v114, 16, v236
    v_and_b32 v115, v14, v236
    v_pk_mul_f32 v[112:113], v[112:113], v[114:115]
    v_cvt_pk_bf16_f32 v108, v112, v113
    v_and_b32 v116, v14, v69
    v_and_b32 v117, v14, v71
    v_lshlrev_b32 v118, 16, v237
    v_and_b32 v119, v14, v237
    v_pk_mul_f32 v[116:117], v[116:117], v[118:119]
    v_cvt_pk_bf16_f32 v109, v116, v117
    v_and_b32 v112, v14, v73
    v_and_b32 v113, v14, v75
    v_lshlrev_b32 v114, 16, v238
    v_and_b32 v115, v14, v238
    v_pk_mul_f32 v[112:113], v[112:113], v[114:115]
    v_cvt_pk_bf16_f32 v110, v112, v113
    v_and_b32 v116, v14, v77
    v_and_b32 v117, v14, v79
    v_lshlrev_b32 v118, 16, v239
    v_and_b32 v119, v14, v239
    v_pk_mul_f32 v[116:117], v[116:117], v[118:119]
    v_cvt_pk_bf16_f32 v111, v116, v117
    buffer_store_dwordx4 v[108:111], v5, s[16:19], s25 offen offset:2304
    s_endpgm
L_roleZ:
    v_mov_b32 v4, 0
    v_mov_b32 v5, 0
    v_mov_b32 v6, 0
    v_mov_b32 v7, 0
    v_lshlrev_b32 v2, 4, v0
    s_mov_b32 s16, s62
    s_and_b32 s17, s63, 0xffff
    s_mov_b32 s18, 7159808
    s_mov_b32 s19, 0x20000
    s_mov_b32 s21, 7077888
    buffer_store_dwordx4 v[4:7], v2, s[16:19], s21 offen sc0 sc1
    s_mov_b32 s21, 7086080
    buffer_store_dwordx4 v[4:7], v2, s[16:19], s21 offen sc0 sc1
    s_mov_b32 s21, 7094272
    buffer_store_dwordx4 v[4:7], v2, s[16:19], s21 offen sc0 sc1
    s_mov_b32 s21, 7102464
    buffer_store_dwordx4 v[4:7], v2, s[16:19], s21 offen sc0 sc1
    s_mov_b32 s21, 7110656
    buffer_store_dwordx4 v[4:7], v2, s[16:19], s21 offen sc0 sc1
    s_mov_b32 s21, 7118848
    buffer_store_dwordx4 v[4:7], v2, s[16:19], s21 offen sc0 sc1
    s_mov_b32 s21, 7127040
    buffer_store_dwordx4 v[4:7], v2, s[16:19], s21 offen sc0 sc1
    s_mov_b32 s21, 7135232
    buffer_store_dwordx4 v[4:7], v2, s[16:19], s21 offen sc0 sc1
    s_mov_b32 s21, 7143424
    buffer_store_dwordx4 v[4:7], v2, s[16:19], s21 offen sc0 sc1
    s_mov_b32 s21, 7151616
    buffer_store_dwordx4 v[4:7], v2, s[16:19], s21 offen sc0 sc1
    s_waitcnt vmcnt(0)
    s_barrier
    s_cmp_eq_u32 s3, 0
    s_cbranch_scc0 L_z_done
    v_mov_b32 v4, 1
    v_mov_b32 v5, 0
    s_mov_b64 exec, 1
    global_store_dword v5, v4, s[60:61] sc0 sc1
    s_mov_b64 exec, -1
L_z_done:
L_concat_heads__linear_attn_block__ssm_conv_h3__prompt_kernel_exit:
    s_endpgm
.fill 1024, 4, 0xbf810000
.section .rodata,"a"
.p2align 6
.amdhsa_kernel concat_heads__linear_attn_block__ssm_conv_h3__prompt_kernel
  .amdhsa_next_free_vgpr 256
  .amdhsa_next_free_sgpr 102
  .amdhsa_accum_offset 256
  .amdhsa_group_segment_fixed_size 0
  .amdhsa_kernarg_size 96
  .amdhsa_user_sgpr_count 2
  .amdhsa_user_sgpr_kernarg_segment_ptr 1
  .amdhsa_system_sgpr_workgroup_id_x 1
.end_amdhsa_kernel
```
